```python
import torch

def _softmax(x, axis=-1):
    return torch.softmax(x, dim=axis)

def _gelu(x):
    return torch.nn.functional.gelu(x, approximate='tanh')

def _silu(x):
    return torch.nn.functional.silu(x)

def _sigmoid(x):
    return torch.sigmoid(x)

def _layernorm(x, axis=-1, eps=1e-05):
    m = x.mean(dim=axis, keepdim=True)
    v = x.var(dim=axis, keepdim=True, unbiased=False)
    return (x - m) / torch.sqrt(v + eps)

def _scatter_add(tgt, idx, src, axis=0):
    return tgt.clone().index_add_(axis, idx, src)

def _segment_sum(src, seg, n):
    out = torch.zeros((n,) + src.shape[1:], dtype=src.dtype)
    return out.index_add_(0, seg, src)

def _pad(x, pw):
    flat = tuple((v for pair in reversed(pw) for v in pair))
    return torch.nn.functional.pad(x, flat)
kernel_name = 'standalone__tree_speculative_verify_tree_attention_over_candidate_token_tree__sampling'

def setup_inputs():

    _w = lambda a: (lambda t: t.to(torch.bfloat16) if t.is_floating_point() else t)(torch.as_tensor(a))
    B, Hq, Hkv, T, C, D = (8, 32, 8, 1, 8192, 128)
    tree_mask = torch.zeros((B, T, T), dtype=float)
    for b in range(B):
        parent = torch.zeros(T, dtype=torch.int64)
        for i in range(1, T):
            parent[i] = int(torch.randint(0, i, (1,)).item())
        for i in range(T):
            j = i
            tree_mask[b, i, j] = 1.0
            while j > 0:
                j = parent[j]
                tree_mask[b, i, j] = 1.0
    return {'q': _w((lambda *s: torch.randn(*s, dtype=torch.bfloat16) * 0.8)(B, Hq, T, D)), 'k_cache': _w((lambda *s: torch.randn(*s, dtype=torch.bfloat16) * 0.8)(B, Hkv, C, D)), 'v_cache': _w((lambda *s: torch.randn(*s, dtype=torch.bfloat16) * 0.05)(B, Hkv, C, D)), 'k_tree': _w((lambda *s: torch.randn(*s, dtype=torch.bfloat16) * 0.8)(B, Hkv, T, D)), 'v_tree': _w((lambda *s: torch.randn(*s, dtype=torch.bfloat16) * 0.05)(B, Hkv, T, D)), 'tree_mask': _w(tree_mask)}

def reference(q, k_cache, v_cache, k_tree, v_tree, tree_mask):
    B, Hq, T, D = q.shape
    Hkv, C = (k_cache.shape[1], k_cache.shape[2])
    rep = Hq // Hkv
    kc = (lambda x, n, axis: torch.repeat_interleave(x, n, dim=axis))(k_cache, rep, axis=1)
    vc = (lambda x, n, axis: torch.repeat_interleave(x, n, dim=axis))(v_cache, rep, axis=1)
    kt = (lambda x, n, axis: torch.repeat_interleave(x, n, dim=axis))(k_tree, rep, axis=1)
    vt = (lambda x, n, axis: torch.repeat_interleave(x, n, dim=axis))(v_tree, rep, axis=1)
    k = torch.concatenate([kc, kt], axis=2)
    v = torch.concatenate([vc, vt], axis=2)
    scale = D ** (-0.5)
    scores = torch.einsum('bhqd,bhkd->bhqk', q, k) * scale
    ctx_mask = torch.ones((B, 1, T, C), dtype=scores.dtype)
    tm = tree_mask[:, None, :, :].clone()
    full_mask = torch.concatenate([ctx_mask, tm], axis=-1)
    scores = scores + (1.0 - full_mask) * -1000000000.0
    p = _softmax(scores, axis=-1)
    return torch.einsum('bhqk,bhkd->bhqd', p, v)
```

```asm
; @launch grid=(256,1,1) block=(192,1,1) lds=90000
.amdgcn_target "amdgcn-amd-amdhsa--gfx950"
.text
.globl standalone__tree_speculative_verify_tree_attention_over_candidate_token_tree__sampling_kernel
.p2align 8
.type standalone__tree_speculative_verify_tree_attention_over_candidate_token_tree__sampling_kernel,@function
standalone__tree_speculative_verify_tree_attention_over_candidate_token_tree__sampling_kernel:
  s_cmp_ge_u32 s2, 256
  s_cbranch_scc1 L_done
  s_load_dwordx16 s[4:19], s[0:1], 0
  s_load_dwordx2 s[20:21], s[0:1], 64
  v_lshrrev_b32 v6, 6, v0
  v_and_b32 v0, 63, v0
  v_readfirstlane_b32 s36, v6
  s_and_b32 s37, s2, 7
  s_lshl_b32 s37, s37, 3
  s_lshr_b32 s38, s2, 5
  s_add_u32 s37, s37, s38
  s_bfe_u32 s38, s2, 0x20003
  s_getpc_b64 s[88:89]
L_pc0:
  s_lshr_b32 s3, s2, 3
  s_mul_i32 s3, s3, 3
  s_add_u32 s3, s3, s36
  s_lshl_b32 s3, s3, 7
  s_min_u32 s3, s3, L_end-L_pc0-4
  s_add_u32 s88, s88, s3
  s_addc_u32 s89, s89, 0
  v_mov_b32 v254, s88
  v_mov_b32 v255, s89
  global_load_dword v253, v[254:255], off
  v_lshlrev_b32 v4, 4, v0
  s_mov_b32 s34, 0x10000
  s_mov_b32 s35, 0x20000
  s_lshl_b32 s42, s37, 10
  s_mov_b32 s40, 0x3e0293ee
  s_cmp_eq_u32 s36, 2
  s_cbranch_scc1 L_svc
  v_and_b32 v7, 48, v0
  v_and_b32 v2, 3, v0
  v_bfe_u32 v6, v0, 2, 2
  v_lshl_add_u32 v6, v6, 8, v7
  v_lshl_add_u32 v2, v2, 10, v6
  v_and_b32 v72, 2, v0
  v_and_b32 v73, 1, v0
  v_lshl_add_u32 v72, v72, 9, v6
  v_lshl_add_u32 v72, v73, 6, v72
  v_add_u32 v73, 64, v72
  v_add_u32 v74, 1920, v72
  v_add_u32 v75, 1984, v72
  s_lshl1_add_u32 s61, s38, s36
  s_bitcmp1_b32 s37, 1
  s_cselect_b32 s39, 120, 0
  s_xor_b32 s61, s61, s39
  s_bitcmp1_b32 s37, 2
  s_cselect_b32 s39, 216, 0
  s_xor_b32 s61, s61, s39
  s_bitcmp1_b32 s37, 3
  s_cselect_b32 s39, 32, 0
  s_xor_b32 s61, s61, s39
  s_bitcmp1_b32 s37, 4
  s_cselect_b32 s39, 200, 0
  s_xor_b32 s61, s61, s39
  s_bitcmp1_b32 s37, 5
  s_cselect_b32 s39, 232, 0
  s_xor_b32 s61, s61, s39
  s_lshl_b32 s61, s61, 13
  s_lshl_b32 s41, s37, 21
  s_mov_b32 s26, 0x200000
  s_mov_b32 s27, 0x20000
  s_add_u32 s39, s61, 0x1000
  s_mov_b32 s97, s61
  s_mov_b32 s96, 0
  s_lshl_b32 s44, s37, 14
  s_mov_b32 s46, 12288
  s_mov_b32 s47, 0x20000
  s_mul_i32 s3, s36, 1536
  s_lshl_b32 s43, s38, 12
  s_add_u32 s43, s43, s3
  v_lshlrev_b32 v254, 2, v4
  v_min_u32 v254, 1472, v254
  s_waitcnt lgkmcnt(0)
  s_add_u32 s24, s6, s41
  s_addc_u32 s25, s7, 0
  s_mov_b32 s32, s4
  s_mov_b32 s33, s5
  s_add_u32 s44, s20, s44
  s_addc_u32 s45, s21, 0
  buffer_load_dword v253, v254, s[44:47], s43 offen sc1
  buffer_load_dwordx4 v[8:11], v6, s[32:35], s42 offen offset:0
  buffer_load_dwordx4 v[12:15], v6, s[32:35], s42 offen offset:64
  buffer_load_dwordx4 v[16:19], v6, s[32:35], s42 offen offset:128
  buffer_load_dwordx4 v[20:23], v6, s[32:35], s42 offen offset:192
  buffer_load_dwordx4 a[0:3], v2, s[24:27], s61 offen offset:0 nt
  buffer_load_dwordx4 a[4:7], v2, s[24:27], s61 offen offset:64 nt
  buffer_load_dwordx4 a[8:11], v2, s[24:27], s61 offen offset:128 nt
  buffer_load_dwordx4 a[12:15], v2, s[24:27], s61 offen offset:192 nt
  buffer_load_dwordx4 a[16:19], v2, s[24:27], s39 offen offset:0 nt
  buffer_load_dwordx4 a[20:23], v2, s[24:27], s39 offen offset:64 nt
  buffer_load_dwordx4 a[24:27], v2, s[24:27], s39 offen offset:128 nt
  buffer_load_dwordx4 a[28:31], v2, s[24:27], s39 offen offset:192 nt
  s_add_u32 s96, s96, 65536
  s_xor_b32 s61, s96, s97
  s_add_u32 s39, s61, 0x1000
  buffer_load_dwordx4 a[32:35], v72, s[24:27], s61 offen offset:0 nt
  buffer_load_dwordx4 a[36:39], v73, s[24:27], s61 offen offset:64 nt
  buffer_load_dwordx4 a[40:43], v74, s[24:27], s61 offen offset:128 nt
  buffer_load_dwordx4 a[44:47], v75, s[24:27], s61 offen offset:192 nt
  buffer_load_dwordx4 a[48:51], v72, s[24:27], s39 offen offset:0 nt
  buffer_load_dwordx4 a[52:55], v73, s[24:27], s39 offen offset:64 nt
  buffer_load_dwordx4 a[56:59], v74, s[24:27], s39 offen offset:128 nt
  buffer_load_dwordx4 a[60:63], v75, s[24:27], s39 offen offset:192 nt
  s_add_u32 s96, s96, 65536
  s_xor_b32 s61, s96, s97
  s_add_u32 s39, s61, 0x1000
  buffer_load_dwordx4 a[64:67], v2, s[24:27], s61 offen offset:0 nt
  buffer_load_dwordx4 a[68:71], v2, s[24:27], s61 offen offset:64 nt
  buffer_load_dwordx4 a[72:75], v2, s[24:27], s61 offen offset:128 nt
  buffer_load_dwordx4 a[76:79], v2, s[24:27], s61 offen offset:192 nt
  buffer_load_dwordx4 a[80:83], v2, s[24:27], s39 offen offset:0 nt
  buffer_load_dwordx4 a[84:87], v2, s[24:27], s39 offen offset:64 nt
  buffer_load_dwordx4 a[88:91], v2, s[24:27], s39 offen offset:128 nt
  buffer_load_dwordx4 a[92:95], v2, s[24:27], s39 offen offset:192 nt
  s_add_u32 s96, s96, 65536
  s_xor_b32 s61, s96, s97
  s_add_u32 s39, s61, 0x1000
  buffer_load_dwordx4 a[96:99], v72, s[24:27], s61 offen offset:0 nt
  buffer_load_dwordx4 a[100:103], v73, s[24:27], s61 offen offset:64 nt
  buffer_load_dwordx4 a[104:107], v74, s[24:27], s61 offen offset:128 nt
  buffer_load_dwordx4 a[108:111], v75, s[24:27], s61 offen offset:192 nt
  buffer_load_dwordx4 a[112:115], v72, s[24:27], s39 offen offset:0 nt
  buffer_load_dwordx4 a[116:119], v73, s[24:27], s39 offen offset:64 nt
  buffer_load_dwordx4 a[120:123], v74, s[24:27], s39 offen offset:128 nt
  buffer_load_dwordx4 a[124:127], v75, s[24:27], s39 offen offset:192 nt
  s_add_u32 s96, s96, 65536
  s_xor_b32 s61, s96, s97
  s_add_u32 s39, s61, 0x1000
  s_add_u32 s28, s8, s41
  s_addc_u32 s29, s9, 0
  v_and_b32 v7, 4, v0
  v_lshlrev_b32 v7, 8, v7
  v_mov_b32 v216, v2
  v_mov_b32 v248, v72
  v_add_u32 v244, 0, v4
  v_add_u32 v240, v244, v7
  v_mov_b32 v217, v2
  v_mov_b32 v249, v73
  v_add_u32 v245, 960, v4
  v_sub_u32 v241, v245, v7
  v_mov_b32 v218, v2
  v_mov_b32 v250, v74
  v_add_u32 v246, 1920, v4
  v_add_u32 v242, v246, v7
  v_mov_b32 v219, v2
  v_mov_b32 v251, v75
  v_add_u32 v247, 2880, v4
  v_sub_u32 v243, v247, v7
  s_mov_b32 s60, 0
  s_mov_b64 s[52:53], 0
  s_mov_b64 s[54:55], 0
  s_mov_b64 s[68:69], 0
  s_mov_b32 s70, 0x1554
  v_mov_b32 v80, 4616
  v_mov_b32 v60, 0xff800000
  v_mov_b32 v62, 0
  v_mov_b32 v24, 0
  v_mov_b32 v220, 0
  v_mov_b32 v228, 0
  v_mov_b32 v25, 0
  v_mov_b32 v221, 0
  v_mov_b32 v229, 0
  v_mov_b32 v26, 0
  v_mov_b32 v222, 0
  v_mov_b32 v230, 0
  v_mov_b32 v27, 0
  v_mov_b32 v223, 0
  v_mov_b32 v231, 0
  v_mov_b32 v28, 0
  v_mov_b32 v224, 0
  v_mov_b32 v232, 0
  v_mov_b32 v29, 0
  v_mov_b32 v225, 0
  v_mov_b32 v233, 0
  v_mov_b32 v30, 0
  v_mov_b32 v226, 0
  v_mov_b32 v234, 0
  v_mov_b32 v31, 0
  v_mov_b32 v227, 0
  v_mov_b32 v235, 0
  s_mov_b32 vcc_lo, 0xaaaaaaaa
  s_mov_b32 vcc_hi, 0xaaaaaaaa
  s_mov_b32 s50, 0x33333333
  s_mov_b32 s51, 0x33333333
  v_mov_b32 v56, 0x0c0c0100
  v_mov_b32 v57, 0x01000c0c
  v_mov_b32 v58, 0x0c0c0302
  v_mov_b32 v59, 0x03020c0c
  v_cndmask_b32 v6, v56, v57, vcc
  v_cndmask_b32 v7, v58, v59, vcc
  v_bfe_u32 v3, v0, 2, 2
  v_lshrrev_b32 v236, 2, v0
  v_mov_b32 v0, 0x0c0c0c0c
  s_lshl_b32 s41, s36, 11
  s_lshl_b32 s42, s36, 3
  s_lshl_b32 s43, s36, 14
  v_cndmask_b32 v56, v0, v6, s[50:51]
  v_cndmask_b32 v57, v6, v0, s[50:51]
  v_cndmask_b32 v58, v0, v7, s[50:51]
  v_cndmask_b32 v59, v7, v0, s[50:51]
  v_lshl_add_u32 v236, v236, 4, s43
  v_lshlrev_b32 v3, 5, v3
  v_add_u32 v3, s42, v3
  v_add_u32 v5, s41, v4
  v_xor_b32 v82, 0x800, v5
  v_lshrrev_b32 v83, 8, v4
  v_lshlrev_b32 v83, 5, v83
  v_add_u32 v84, s42, v83
  v_xor_b32 v85, 8, v84
  v_mov_b32 v86, 1
  v_mov_b32 v146, 0
  v_cndmask_b32 v147, 0, 4, vcc
  s_lshl_b32 s41, s37, 14
  s_add_u32 s44, s20, s41
  s_addc_u32 s45, s21, 0
  s_mov_b32 s46, 0x4000
  s_mov_b32 s47, 0x20000
  s_mov_b64 s[72:73], s[44:45]
  s_cmp_eq_u32 s38, 3
  s_cselect_b32 s74, 16384, 0
  s_mov_b32 s75, 0x20000
  s_lshl_b32 s43, s38, 12
  s_mov_b32 s64, 0
  s_mov_b32 s76, 0
  s_mov_b32 s65, 4096
  s_mov_b32 s77, 1
  s_mov_b32 s66, 8192
  s_mov_b32 s78, 2
  s_mov_b32 s79, 7
  s_mov_b32 s56, s16
  s_mov_b32 s57, s17
  s_mov_b32 s58, 0x10000
  s_mov_b32 s59, 0x20000
  s_lshl_b32 s62, s37, 10
  s_mov_b64 s[86:87], 1
  s_mov_b64 s[88:89], -1
  s_mov_b64 s[90:91], 0x1111
  s_mov_b32 s22, 0x11111111
  s_mov_b32 s23, 0x11111111
  s_mov_b32 s10, 0xf0f0f0f0
  s_mov_b32 s11, 0xf0f0f0f0
  s_waitcnt vmcnt(32)
  v_cndmask_b32 v64, v8, v12, vcc
  v_cndmask_b32 v65, v9, v13, vcc
  v_cndmask_b32 v66, v10, v14, vcc
  v_cndmask_b32 v67, v11, v15, vcc
  v_cndmask_b32 v68, v16, v20, vcc
  v_cndmask_b32 v69, v17, v21, vcc
  v_cndmask_b32 v70, v18, v22, vcc
  v_cndmask_b32 v71, v19, v23, vcc
L_kl:
  s_cmp_lg_u32 s60, 7
  s_cbranch_scc1 L_ks
  s_mov_b64 s[24:25], s[28:29]
  s_mov_b32 s96, 0
  s_mov_b32 s61, s97
  s_add_u32 s39, s61, 0x1000
  v_mov_b32 v216, v240
  v_mov_b32 v72, v244
  v_mov_b32 v248, v244
  v_mov_b32 v217, v241
  v_mov_b32 v73, v245
  v_mov_b32 v249, v245
  v_mov_b32 v218, v242
  v_mov_b32 v74, v246
  v_mov_b32 v250, v246
  v_mov_b32 v219, v243
  v_mov_b32 v75, v247
  v_mov_b32 v251, v247
L_ks:
  s_waitcnt vmcnt(24)
  s_memrealtime s[50:51]
  ds_read_b32 v81, v80
  s_cmp_lg_u32 s52, 0
  s_cbranch_scc1 L_qa0
  v_mfma_f32_16x16x32_bf16 v[32:35], a[0:3], v[8:11], 0
  v_mfma_f32_16x16x32_bf16 v[36:39], a[16:19], v[8:11], 0
  v_mfma_f32_16x16x32_bf16 v[32:35], a[4:7], v[12:15], v[32:35]
  v_mfma_f32_16x16x32_bf16 v[36:39], a[20:23], v[12:15], v[36:39]
  v_mfma_f32_16x16x32_bf16 v[32:35], a[8:11], v[16:19], v[32:35]
  v_mfma_f32_16x16x32_bf16 v[36:39], a[24:27], v[16:19], v[36:39]
  v_mfma_f32_16x16x32_bf16 v[32:35], a[12:15], v[20:23], v[32:35]
  v_mfma_f32_16x16x32_bf16 v[36:39], a[28:31], v[20:23], v[36:39]
  s_branch L_qb0
L_qa0:
  v_mfma_f32_16x16x32_bf16 v[40:43], a[0:3], v[64:67], 0
  v_mfma_f32_16x16x32_bf16 v[44:47], a[8:11], v[64:67], 0
  v_mfma_f32_16x16x32_bf16 v[48:51], a[16:19], v[64:67], 0
  v_mfma_f32_16x16x32_bf16 v[52:55], a[24:27], v[64:67], 0
  v_mfma_f32_16x16x32_bf16 v[40:43], a[4:7], v[68:71], v[40:43]
  v_mfma_f32_16x16x32_bf16 v[44:47], a[12:15], v[68:71], v[44:47]
  v_mfma_f32_16x16x32_bf16 v[48:51], a[20:23], v[68:71], v[48:51]
  v_mfma_f32_16x16x32_bf16 v[52:55], a[28:31], v[68:71], v[52:55]
  s_nop 4
  v_cndmask_b32 v32, v40, v41, vcc
  v_cndmask_b32 v33, v42, v43, vcc
  v_cndmask_b32 v34, v44, v45, vcc
  v_cndmask_b32 v35, v46, v47, vcc
  v_cndmask_b32 v36, v48, v49, vcc
  v_cndmask_b32 v37, v50, v51, vcc
  v_cndmask_b32 v38, v52, v53, vcc
  v_cndmask_b32 v39, v54, v55, vcc
  v_add_f32_dpp v32, v32, v32 quad_perm:[1,0,3,2] row_mask:0xf bank_mask:0xf
  v_add_f32_dpp v33, v33, v33 quad_perm:[1,0,3,2] row_mask:0xf bank_mask:0xf
  v_add_f32_dpp v34, v34, v34 quad_perm:[1,0,3,2] row_mask:0xf bank_mask:0xf
  v_add_f32_dpp v35, v35, v35 quad_perm:[1,0,3,2] row_mask:0xf bank_mask:0xf
  v_add_f32_dpp v36, v36, v36 quad_perm:[1,0,3,2] row_mask:0xf bank_mask:0xf
  v_add_f32_dpp v37, v37, v37 quad_perm:[1,0,3,2] row_mask:0xf bank_mask:0xf
  v_add_f32_dpp v38, v38, v38 quad_perm:[1,0,3,2] row_mask:0xf bank_mask:0xf
  v_add_f32_dpp v39, v39, v39 quad_perm:[1,0,3,2] row_mask:0xf bank_mask:0xf
L_qb0:
  s_waitcnt lgkmcnt(0)
  v_readfirstlane_b32 s41, v81
  v_add_u32 v80, 4, v80
  s_sub_u32 s41, s50, s41
  s_cmp_gt_i32 s41, 0
  s_cselect_b64 s[52:53], s[68:69], 0
  v_cndmask_b32 v76, v216, v72, s[52:53]
  v_cndmask_b32 v77, v217, v73, s[52:53]
  v_cndmask_b32 v78, v218, v74, s[52:53]
  v_cndmask_b32 v79, v219, v75, s[52:53]
  buffer_load_dwordx4 a[0:3], v76, s[24:27], s61 offen offset:0 nt
  buffer_load_dwordx4 a[4:7], v77, s[24:27], s61 offen offset:64 nt
  buffer_load_dwordx4 a[8:11], v78, s[24:27], s61 offen offset:128 nt
  buffer_load_dwordx4 a[12:15], v79, s[24:27], s61 offen offset:192 nt
  buffer_load_dwordx4 a[16:19], v76, s[24:27], s39 offen offset:0 nt
  buffer_load_dwordx4 a[20:23], v77, s[24:27], s39 offen offset:64 nt
  buffer_load_dwordx4 a[24:27], v78, s[24:27], s39 offen offset:128 nt
  buffer_load_dwordx4 a[28:31], v79, s[24:27], s39 offen offset:192 nt
  s_add_u32 s96, s96, 65536
  s_xor_b32 s61, s96, s97
  s_add_u32 s39, s61, 0x1000
  s_mov_b64 exec, s[22:23]
  ds_write_b128 v236, v[32:35] offset:8192
  ds_write_b128 v236, v[36:39] offset:8448
  s_mov_b64 exec, s[88:89]
  v_max3_f32 v60, v32, v33, v60
  v_max3_f32 v60, v34, v35, v60
  v_max3_f32 v60, v36, v37, v60
  v_max3_f32 v60, v38, v39, v60
  s_waitcnt vmcnt(24)
  v_mfma_f32_16x16x32_bf16 v[200:203], a[32:35], v[64:67], 0
  v_mfma_f32_16x16x32_bf16 v[204:207], a[40:43], v[64:67], 0
  v_mfma_f32_16x16x32_bf16 v[208:211], a[48:51], v[64:67], 0
  v_mfma_f32_16x16x32_bf16 v[212:215], a[56:59], v[64:67], 0
  v_mfma_f32_16x16x32_bf16 v[200:203], a[36:39], v[68:71], v[200:203]
  v_mfma_f32_16x16x32_bf16 v[204:207], a[44:47], v[68:71], v[204:207]
  v_mfma_f32_16x16x32_bf16 v[208:211], a[52:55], v[68:71], v[208:211]
  v_mfma_f32_16x16x32_bf16 v[212:215], a[60:63], v[68:71], v[212:215]
  buffer_load_dwordx4 a[32:35], v248, s[24:27], s61 offen offset:0 nt
  buffer_load_dwordx4 a[36:39], v249, s[24:27], s61 offen offset:64 nt
  buffer_load_dwordx4 a[40:43], v250, s[24:27], s61 offen offset:128 nt
  buffer_load_dwordx4 a[44:47], v251, s[24:27], s61 offen offset:192 nt
  buffer_load_dwordx4 a[48:51], v248, s[24:27], s39 offen offset:0 nt
  buffer_load_dwordx4 a[52:55], v249, s[24:27], s39 offen offset:64 nt
  buffer_load_dwordx4 a[56:59], v250, s[24:27], s39 offen offset:128 nt
  buffer_load_dwordx4 a[60:63], v251, s[24:27], s39 offen offset:192 nt
  s_add_u32 s96, s96, 65536
  s_xor_b32 s61, s96, s97
  s_add_u32 s39, s61, 0x1000
  v_cndmask_b32 v192, v200, v201, vcc
  v_cndmask_b32 v193, v202, v203, vcc
  v_cndmask_b32 v194, v204, v205, vcc
  v_cndmask_b32 v195, v206, v207, vcc
  v_cndmask_b32 v196, v208, v209, vcc
  v_cndmask_b32 v197, v210, v211, vcc
  v_cndmask_b32 v198, v212, v213, vcc
  v_cndmask_b32 v199, v214, v215, vcc
  v_add_f32_dpp v192, v192, v192 quad_perm:[1,0,3,2] row_mask:0xf bank_mask:0xf
  v_add_f32_dpp v193, v193, v193 quad_perm:[1,0,3,2] row_mask:0xf bank_mask:0xf
  v_add_f32_dpp v194, v194, v194 quad_perm:[1,0,3,2] row_mask:0xf bank_mask:0xf
  v_add_f32_dpp v195, v195, v195 quad_perm:[1,0,3,2] row_mask:0xf bank_mask:0xf
  v_add_f32_dpp v196, v196, v196 quad_perm:[1,0,3,2] row_mask:0xf bank_mask:0xf
  v_add_f32_dpp v197, v197, v197 quad_perm:[1,0,3,2] row_mask:0xf bank_mask:0xf
  v_add_f32_dpp v198, v198, v198 quad_perm:[1,0,3,2] row_mask:0xf bank_mask:0xf
  v_add_f32_dpp v199, v199, v199 quad_perm:[1,0,3,2] row_mask:0xf bank_mask:0xf
  s_mov_b64 exec, s[22:23]
  ds_write_b128 v236, v[192:195] offset:8704
  ds_write_b128 v236, v[196:199] offset:8960
  s_mov_b64 exec, s[88:89]
  v_max3_f32 v60, v192, v193, v60
  v_max3_f32 v60, v194, v195, v60
  v_max3_f32 v60, v196, v197, v60
  v_max3_f32 v60, v198, v199, v60
  s_waitcnt vmcnt(24)
  s_memrealtime s[50:51]
  ds_read_b32 v81, v80
  s_cmp_lg_u32 s54, 0
  s_cbranch_scc1 L_qa1
  v_mfma_f32_16x16x32_bf16 v[32:35], a[64:67], v[8:11], 0
  v_mfma_f32_16x16x32_bf16 v[36:39], a[80:83], v[8:11], 0
  v_mfma_f32_16x16x32_bf16 v[32:35], a[68:71], v[12:15], v[32:35]
  v_mfma_f32_16x16x32_bf16 v[36:39], a[84:87], v[12:15], v[36:39]
  v_mfma_f32_16x16x32_bf16 v[32:35], a[72:75], v[16:19], v[32:35]
  v_mfma_f32_16x16x32_bf16 v[36:39], a[88:91], v[16:19], v[36:39]
  v_mfma_f32_16x16x32_bf16 v[32:35], a[76:79], v[20:23], v[32:35]
  v_mfma_f32_16x16x32_bf16 v[36:39], a[92:95], v[20:23], v[36:39]
  s_branch L_qb1
L_qa1:
  v_mfma_f32_16x16x32_bf16 v[40:43], a[64:67], v[64:67], 0
  v_mfma_f32_16x16x32_bf16 v[44:47], a[72:75], v[64:67], 0
  v_mfma_f32_16x16x32_bf16 v[48:51], a[80:83], v[64:67], 0
  v_mfma_f32_16x16x32_bf16 v[52:55], a[88:91], v[64:67], 0
  v_mfma_f32_16x16x32_bf16 v[40:43], a[68:71], v[68:71], v[40:43]
  v_mfma_f32_16x16x32_bf16 v[44:47], a[76:79], v[68:71], v[44:47]
  v_mfma_f32_16x16x32_bf16 v[48:51], a[84:87], v[68:71], v[48:51]
  v_mfma_f32_16x16x32_bf16 v[52:55], a[92:95], v[68:71], v[52:55]
  s_nop 4
  v_cndmask_b32 v32, v40, v41, vcc
  v_cndmask_b32 v33, v42, v43, vcc
  v_cndmask_b32 v34, v44, v45, vcc
  v_cndmask_b32 v35, v46, v47, vcc
  v_cndmask_b32 v36, v48, v49, vcc
  v_cndmask_b32 v37, v50, v51, vcc
  v_cndmask_b32 v38, v52, v53, vcc
  v_cndmask_b32 v39, v54, v55, vcc
  v_add_f32_dpp v32, v32, v32 quad_perm:[1,0,3,2] row_mask:0xf bank_mask:0xf
  v_add_f32_dpp v33, v33, v33 quad_perm:[1,0,3,2] row_mask:0xf bank_mask:0xf
  v_add_f32_dpp v34, v34, v34 quad_perm:[1,0,3,2] row_mask:0xf bank_mask:0xf
  v_add_f32_dpp v35, v35, v35 quad_perm:[1,0,3,2] row_mask:0xf bank_mask:0xf
  v_add_f32_dpp v36, v36, v36 quad_perm:[1,0,3,2] row_mask:0xf bank_mask:0xf
  v_add_f32_dpp v37, v37, v37 quad_perm:[1,0,3,2] row_mask:0xf bank_mask:0xf
  v_add_f32_dpp v38, v38, v38 quad_perm:[1,0,3,2] row_mask:0xf bank_mask:0xf
  v_add_f32_dpp v39, v39, v39 quad_perm:[1,0,3,2] row_mask:0xf bank_mask:0xf
L_qb1:
  s_waitcnt lgkmcnt(0)
  v_readfirstlane_b32 s41, v81
  v_add_u32 v80, 4, v80
  s_sub_u32 s41, s50, s41
  s_cmp_gt_i32 s41, 0
  s_cselect_b64 s[54:55], s[68:69], 0
  v_cndmask_b32 v76, v216, v72, s[54:55]
  v_cndmask_b32 v77, v217, v73, s[54:55]
  v_cndmask_b32 v78, v218, v74, s[54:55]
  v_cndmask_b32 v79, v219, v75, s[54:55]
  buffer_load_dwordx4 a[64:67], v76, s[24:27], s61 offen offset:0 nt
  buffer_load_dwordx4 a[68:71], v77, s[24:27], s61 offen offset:64 nt
  buffer_load_dwordx4 a[72:75], v78, s[24:27], s61 offen offset:128 nt
  buffer_load_dwordx4 a[76:79], v79, s[24:27], s61 offen offset:192 nt
  buffer_load_dwordx4 a[80:83], v76, s[24:27], s39 offen offset:0 nt
  buffer_load_dwordx4 a[84:87], v77, s[24:27], s39 offen offset:64 nt
  buffer_load_dwordx4 a[88:91], v78, s[24:27], s39 offen offset:128 nt
  buffer_load_dwordx4 a[92:95], v79, s[24:27], s39 offen offset:192 nt
  s_add_u32 s96, s96, 65536
  s_xor_b32 s61, s96, s97
  s_add_u32 s39, s61, 0x1000
  s_mov_b64 exec, s[22:23]
  ds_write_b128 v236, v[32:35] offset:9216
  ds_write_b128 v236, v[36:39] offset:9472
  s_mov_b64 exec, s[88:89]
  v_max3_f32 v60, v32, v33, v60
  v_max3_f32 v60, v34, v35, v60
  v_max3_f32 v60, v36, v37, v60
  v_max3_f32 v60, v38, v39, v60
  s_waitcnt vmcnt(24)
  v_mfma_f32_16x16x32_bf16 v[200:203], a[96:99], v[64:67], 0
  v_mfma_f32_16x16x32_bf16 v[204:207], a[104:107], v[64:67], 0
  v_mfma_f32_16x16x32_bf16 v[208:211], a[112:115], v[64:67], 0
  v_mfma_f32_16x16x32_bf16 v[212:215], a[120:123], v[64:67], 0
  v_mfma_f32_16x16x32_bf16 v[200:203], a[100:103], v[68:71], v[200:203]
  v_mfma_f32_16x16x32_bf16 v[204:207], a[108:111], v[68:71], v[204:207]
  v_mfma_f32_16x16x32_bf16 v[208:211], a[116:119], v[68:71], v[208:211]
  v_mfma_f32_16x16x32_bf16 v[212:215], a[124:127], v[68:71], v[212:215]
  buffer_load_dwordx4 a[96:99], v248, s[24:27], s61 offen offset:0 nt
  buffer_load_dwordx4 a[100:103], v249, s[24:27], s61 offen offset:64 nt
  buffer_load_dwordx4 a[104:107], v250, s[24:27], s61 offen offset:128 nt
  buffer_load_dwordx4 a[108:111], v251, s[24:27], s61 offen offset:192 nt
  buffer_load_dwordx4 a[112:115], v248, s[24:27], s39 offen offset:0 nt
  buffer_load_dwordx4 a[116:119], v249, s[24:27], s39 offen offset:64 nt
  buffer_load_dwordx4 a[120:123], v250, s[24:27], s39 offen offset:128 nt
  buffer_load_dwordx4 a[124:127], v251, s[24:27], s39 offen offset:192 nt
  s_add_u32 s96, s96, 65536
  s_xor_b32 s61, s96, s97
  s_add_u32 s39, s61, 0x1000
  v_cndmask_b32 v192, v200, v201, vcc
  v_cndmask_b32 v193, v202, v203, vcc
  v_cndmask_b32 v194, v204, v205, vcc
  v_cndmask_b32 v195, v206, v207, vcc
  v_cndmask_b32 v196, v208, v209, vcc
  v_cndmask_b32 v197, v210, v211, vcc
  v_cndmask_b32 v198, v212, v213, vcc
  v_cndmask_b32 v199, v214, v215, vcc
  v_add_f32_dpp v192, v192, v192 quad_perm:[1,0,3,2] row_mask:0xf bank_mask:0xf
  v_add_f32_dpp v193, v193, v193 quad_perm:[1,0,3,2] row_mask:0xf bank_mask:0xf
  v_add_f32_dpp v194, v194, v194 quad_perm:[1,0,3,2] row_mask:0xf bank_mask:0xf
  v_add_f32_dpp v195, v195, v195 quad_perm:[1,0,3,2] row_mask:0xf bank_mask:0xf
  v_add_f32_dpp v196, v196, v196 quad_perm:[1,0,3,2] row_mask:0xf bank_mask:0xf
  v_add_f32_dpp v197, v197, v197 quad_perm:[1,0,3,2] row_mask:0xf bank_mask:0xf
  v_add_f32_dpp v198, v198, v198 quad_perm:[1,0,3,2] row_mask:0xf bank_mask:0xf
  v_add_f32_dpp v199, v199, v199 quad_perm:[1,0,3,2] row_mask:0xf bank_mask:0xf
  s_mov_b64 exec, s[22:23]
  ds_write_b128 v236, v[192:195] offset:9728
  ds_write_b128 v236, v[196:199] offset:9984
  s_mov_b64 exec, s[88:89]
  v_max3_f32 v60, v192, v193, v60
  v_max3_f32 v60, v194, v195, v60
  v_max3_f32 v60, v196, v197, v60
  v_max3_f32 v60, v198, v199, v60
  s_bitcmp0_b32 s70, s60
  s_cbranch_scc1 L_kl_nb
  s_barrier
  s_mov_b64 s[68:69], -1
L_kl_nb:
  v_add_u32 v236, 2048, v236
  s_add_u32 s60, s60, 1
  s_cmp_lt_u32 s60, 8
  s_cbranch_scc1 L_kl
L_tr:
  v_subrev_u32 v236, 16384, v236
  ds_read_b128 v[32:35], v236 offset:8192
  ds_read_b128 v[36:39], v236 offset:8448
  ds_read_b128 v[192:195], v236 offset:8704
  ds_read_b128 v[196:199], v236 offset:8960
  v_mov_b32 v7, v60
  s_nop 1
  v_permlane32_swap_b32 v60, v7
  v_max_f32 v60, v60, v7
  v_mov_b32 v7, v60
  s_nop 1
  v_permlane16_swap_b32 v60, v7
  v_max_f32 v60, v60, v7
  v_mul_f32 v61, s40, v60
  s_waitcnt lgkmcnt(0)
  v_fma_f32 v32, v32, s40, -v61
  v_fma_f32 v33, v33, s40, -v61
  v_fma_f32 v34, v34, s40, -v61
  v_fma_f32 v35, v35, s40, -v61
  v_fma_f32 v36, v36, s40, -v61
  v_fma_f32 v37, v37, s40, -v61
  v_fma_f32 v38, v38, s40, -v61
  v_fma_f32 v39, v39, s40, -v61
  v_exp_f32 v32, v32
  v_exp_f32 v33, v33
  v_exp_f32 v34, v34
  v_exp_f32 v35, v35
  v_exp_f32 v36, v36
  v_exp_f32 v37, v37
  v_exp_f32 v38, v38
  v_exp_f32 v39, v39
  v_add_f32 v6, v32, v33
  v_add_f32 v7, v34, v35
  v_add_f32 v62, v62, v6
  v_add_f32 v6, v36, v37
  v_add_f32 v62, v62, v7
  v_add_f32 v7, v38, v39
  v_add_f32 v62, v62, v6
  v_add_f32 v62, v62, v7
  v_cvt_pk_bf16_f32 v32, v32, v33
  v_cvt_pk_bf16_f32 v33, v34, v35
  v_cvt_pk_bf16_f32 v34, v36, v37
  v_cvt_pk_bf16_f32 v35, v38, v39
  v_perm_b32 v40, v32, v32, v56
  v_perm_b32 v41, v32, v32, v57
  v_perm_b32 v42, v32, v32, v58
  v_perm_b32 v43, v32, v32, v59
  v_perm_b32 v44, v33, v33, v56
  v_perm_b32 v45, v33, v33, v57
  v_perm_b32 v46, v33, v33, v58
  v_perm_b32 v47, v33, v33, v59
  v_perm_b32 v48, v34, v34, v56
  v_perm_b32 v49, v34, v34, v57
  v_perm_b32 v50, v34, v34, v58
  v_perm_b32 v51, v34, v34, v59
  v_perm_b32 v52, v35, v35, v56
  v_perm_b32 v53, v35, v35, v57
  v_perm_b32 v54, v35, v35, v58
  v_perm_b32 v55, v35, v35, v59
  v_fma_f32 v192, v192, s40, -v61
  v_fma_f32 v193, v193, s40, -v61
  v_fma_f32 v194, v194, s40, -v61
  v_fma_f32 v195, v195, s40, -v61
  v_fma_f32 v196, v196, s40, -v61
  v_fma_f32 v197, v197, s40, -v61
  v_fma_f32 v198, v198, s40, -v61
  v_fma_f32 v199, v199, s40, -v61
  v_exp_f32 v192, v192
  v_exp_f32 v193, v193
  v_exp_f32 v194, v194
  v_exp_f32 v195, v195
  v_exp_f32 v196, v196
  v_exp_f32 v197, v197
  v_exp_f32 v198, v198
  v_exp_f32 v199, v199
  v_add_f32 v6, v192, v193
  v_add_f32 v7, v194, v195
  v_add_f32 v62, v62, v6
  v_add_f32 v6, v196, v197
  v_add_f32 v62, v62, v7
  v_add_f32 v7, v198, v199
  v_add_f32 v62, v62, v6
  v_add_f32 v62, v62, v7
  v_cvt_pk_bf16_f32 v192, v192, v193
  v_cvt_pk_bf16_f32 v193, v194, v195
  v_cvt_pk_bf16_f32 v194, v196, v197
  v_cvt_pk_bf16_f32 v195, v198, v199
  v_perm_b32 v200, v192, v192, v56
  v_perm_b32 v201, v192, v192, v57
  v_perm_b32 v202, v192, v192, v58
  v_perm_b32 v203, v192, v192, v59
  v_perm_b32 v204, v193, v193, v56
  v_perm_b32 v205, v193, v193, v57
  v_perm_b32 v206, v193, v193, v58
  v_perm_b32 v207, v193, v193, v59
  v_perm_b32 v208, v194, v194, v56
  v_perm_b32 v209, v194, v194, v57
  v_perm_b32 v210, v194, v194, v58
  v_perm_b32 v211, v194, v194, v59
  v_perm_b32 v212, v195, v195, v56
  v_perm_b32 v213, v195, v195, v57
  v_perm_b32 v214, v195, v195, v58
  v_perm_b32 v215, v195, v195, v59
L_vl:
  ds_read_b128 v[32:35], v236 offset:9216
  ds_read_b128 v[36:39], v236 offset:9472
  ds_read_b128 v[192:195], v236 offset:9728
  ds_read_b128 v[196:199], v236 offset:9984
  s_waitcnt vmcnt(24)
  s_memrealtime s[50:51]
  ds_read_b32 v81, v80
  s_cmp_lg_u32 s52, 0
  s_cbranch_scc1 L_qa2
  v_mfma_f32_16x16x16_bf16 v[220:223], v[40:41], a[0:1], v[220:223]
  v_mfma_f32_16x16x16_bf16 v[224:227], v[40:41], a[2:3], v[224:227]
  v_mfma_f32_16x16x16_bf16 v[228:231], v[42:43], a[0:1], v[228:231]
  v_mfma_f32_16x16x16_bf16 v[232:235], v[42:43], a[2:3], v[232:235]
  v_mfma_f32_16x16x16_bf16 v[220:223], v[42:43], a[4:5], v[220:223]
  v_mfma_f32_16x16x16_bf16 v[224:227], v[42:43], a[6:7], v[224:227]
  v_mfma_f32_16x16x16_bf16 v[228:231], v[40:41], a[4:5], v[228:231]
  v_mfma_f32_16x16x16_bf16 v[232:235], v[40:41], a[6:7], v[232:235]
  v_mfma_f32_16x16x16_bf16 v[220:223], v[44:45], a[8:9], v[220:223]
  v_mfma_f32_16x16x16_bf16 v[224:227], v[44:45], a[10:11], v[224:227]
  v_mfma_f32_16x16x16_bf16 v[228:231], v[46:47], a[8:9], v[228:231]
  v_mfma_f32_16x16x16_bf16 v[232:235], v[46:47], a[10:11], v[232:235]
  v_mfma_f32_16x16x16_bf16 v[220:223], v[46:47], a[12:13], v[220:223]
  v_mfma_f32_16x16x16_bf16 v[224:227], v[46:47], a[14:15], v[224:227]
  v_mfma_f32_16x16x16_bf16 v[228:231], v[44:45], a[12:13], v[228:231]
  v_mfma_f32_16x16x16_bf16 v[232:235], v[44:45], a[14:15], v[232:235]
  v_mfma_f32_16x16x16_bf16 v[220:223], v[48:49], a[16:17], v[220:223]
  v_mfma_f32_16x16x16_bf16 v[224:227], v[48:49], a[18:19], v[224:227]
  v_mfma_f32_16x16x16_bf16 v[228:231], v[50:51], a[16:17], v[228:231]
  v_mfma_f32_16x16x16_bf16 v[232:235], v[50:51], a[18:19], v[232:235]
  v_mfma_f32_16x16x16_bf16 v[220:223], v[50:51], a[20:21], v[220:223]
  v_mfma_f32_16x16x16_bf16 v[224:227], v[50:51], a[22:23], v[224:227]
  v_mfma_f32_16x16x16_bf16 v[228:231], v[48:49], a[20:21], v[228:231]
  v_mfma_f32_16x16x16_bf16 v[232:235], v[48:49], a[22:23], v[232:235]
  v_mfma_f32_16x16x16_bf16 v[220:223], v[52:53], a[24:25], v[220:223]
  v_mfma_f32_16x16x16_bf16 v[224:227], v[52:53], a[26:27], v[224:227]
  v_mfma_f32_16x16x16_bf16 v[228:231], v[54:55], a[24:25], v[228:231]
  v_mfma_f32_16x16x16_bf16 v[232:235], v[54:55], a[26:27], v[232:235]
  v_mfma_f32_16x16x16_bf16 v[220:223], v[54:55], a[28:29], v[220:223]
  v_mfma_f32_16x16x16_bf16 v[224:227], v[54:55], a[30:31], v[224:227]
  v_mfma_f32_16x16x16_bf16 v[228:231], v[52:53], a[28:29], v[228:231]
  v_mfma_f32_16x16x16_bf16 v[232:235], v[52:53], a[30:31], v[232:235]
  s_branch L_qb2
L_qa2:
  v_mfma_f32_16x16x16_bf16 v[24:27], v[40:41], a[0:1], v[24:27]
  v_mfma_f32_16x16x16_bf16 v[28:31], v[40:41], a[2:3], v[28:31]
  v_mfma_f32_16x16x16_bf16 v[24:27], v[42:43], a[4:5], v[24:27]
  v_mfma_f32_16x16x16_bf16 v[28:31], v[42:43], a[6:7], v[28:31]
  v_mfma_f32_16x16x16_bf16 v[24:27], v[44:45], a[8:9], v[24:27]
  v_mfma_f32_16x16x16_bf16 v[28:31], v[44:45], a[10:11], v[28:31]
  v_mfma_f32_16x16x16_bf16 v[24:27], v[46:47], a[12:13], v[24:27]
  v_mfma_f32_16x16x16_bf16 v[28:31], v[46:47], a[14:15], v[28:31]
  v_mfma_f32_16x16x16_bf16 v[24:27], v[48:49], a[16:17], v[24:27]
  v_mfma_f32_16x16x16_bf16 v[28:31], v[48:49], a[18:19], v[28:31]
  v_mfma_f32_16x16x16_bf16 v[24:27], v[50:51], a[20:21], v[24:27]
  v_mfma_f32_16x16x16_bf16 v[28:31], v[50:51], a[22:23], v[28:31]
  v_mfma_f32_16x16x16_bf16 v[24:27], v[52:53], a[24:25], v[24:27]
  v_mfma_f32_16x16x16_bf16 v[28:31], v[52:53], a[26:27], v[28:31]
  v_mfma_f32_16x16x16_bf16 v[24:27], v[54:55], a[28:29], v[24:27]
  v_mfma_f32_16x16x16_bf16 v[28:31], v[54:55], a[30:31], v[28:31]
L_qb2:
  s_waitcnt lgkmcnt(0)
  v_readfirstlane_b32 s41, v81
  v_add_u32 v80, 4, v80
  s_sub_u32 s41, s50, s41
  s_cmp_gt_i32 s41, 0
  s_cselect_b64 s[52:53], s[68:69], 0
  v_cndmask_b32 v76, v216, v72, s[52:53]
  v_cndmask_b32 v77, v217, v73, s[52:53]
  v_cndmask_b32 v78, v218, v74, s[52:53]
  v_cndmask_b32 v79, v219, v75, s[52:53]
  buffer_load_dwordx4 a[0:3], v76, s[24:27], s61 offen offset:0 nt
  buffer_load_dwordx4 a[4:7], v77, s[24:27], s61 offen offset:64 nt
  buffer_load_dwordx4 a[8:11], v78, s[24:27], s61 offen offset:128 nt
  buffer_load_dwordx4 a[12:15], v79, s[24:27], s61 offen offset:192 nt
  buffer_load_dwordx4 a[16:19], v76, s[24:27], s39 offen offset:0 nt
  buffer_load_dwordx4 a[20:23], v77, s[24:27], s39 offen offset:64 nt
  buffer_load_dwordx4 a[24:27], v78, s[24:27], s39 offen offset:128 nt
  buffer_load_dwordx4 a[28:31], v79, s[24:27], s39 offen offset:192 nt
  s_add_u32 s96, s96, 65536
  s_xor_b32 s61, s96, s97
  s_add_u32 s39, s61, 0x1000
  v_fma_f32 v32, v32, s40, -v61
  v_fma_f32 v33, v33, s40, -v61
  v_fma_f32 v34, v34, s40, -v61
  v_fma_f32 v35, v35, s40, -v61
  v_fma_f32 v36, v36, s40, -v61
  v_fma_f32 v37, v37, s40, -v61
  v_fma_f32 v38, v38, s40, -v61
  v_fma_f32 v39, v39, s40, -v61
  v_exp_f32 v32, v32
  v_exp_f32 v33, v33
  v_exp_f32 v34, v34
  v_exp_f32 v35, v35
  v_exp_f32 v36, v36
  v_exp_f32 v37, v37
  v_exp_f32 v38, v38
  v_exp_f32 v39, v39
  v_add_f32 v6, v32, v33
  v_add_f32 v7, v34, v35
  v_add_f32 v62, v62, v6
  v_add_f32 v6, v36, v37
  v_add_f32 v62, v62, v7
  v_add_f32 v7, v38, v39
  v_add_f32 v62, v62, v6
  v_add_f32 v62, v62, v7
  v_cvt_pk_bf16_f32 v32, v32, v33
  v_cvt_pk_bf16_f32 v33, v34, v35
  v_cvt_pk_bf16_f32 v34, v36, v37
  v_cvt_pk_bf16_f32 v35, v38, v39
  v_perm_b32 v40, v32, v32, v56
  v_perm_b32 v41, v32, v32, v57
  v_perm_b32 v42, v32, v32, v58
  v_perm_b32 v43, v32, v32, v59
  v_perm_b32 v44, v33, v33, v56
  v_perm_b32 v45, v33, v33, v57
  v_perm_b32 v46, v33, v33, v58
  v_perm_b32 v47, v33, v33, v59
  v_perm_b32 v48, v34, v34, v56
  v_perm_b32 v49, v34, v34, v57
  v_perm_b32 v50, v34, v34, v58
  v_perm_b32 v51, v34, v34, v59
  v_perm_b32 v52, v35, v35, v56
  v_perm_b32 v53, v35, v35, v57
  v_perm_b32 v54, v35, v35, v58
  v_perm_b32 v55, v35, v35, v59
  s_waitcnt vmcnt(24)
  v_mfma_f32_16x16x16_bf16 v[24:27], v[200:201], a[32:33], v[24:27]
  v_mfma_f32_16x16x16_bf16 v[28:31], v[200:201], a[34:35], v[28:31]
  v_mfma_f32_16x16x16_bf16 v[24:27], v[202:203], a[36:37], v[24:27]
  v_mfma_f32_16x16x16_bf16 v[28:31], v[202:203], a[38:39], v[28:31]
  v_mfma_f32_16x16x16_bf16 v[24:27], v[204:205], a[40:41], v[24:27]
  v_mfma_f32_16x16x16_bf16 v[28:31], v[204:205], a[42:43], v[28:31]
  v_mfma_f32_16x16x16_bf16 v[24:27], v[206:207], a[44:45], v[24:27]
  v_mfma_f32_16x16x16_bf16 v[28:31], v[206:207], a[46:47], v[28:31]
  v_mfma_f32_16x16x16_bf16 v[24:27], v[208:209], a[48:49], v[24:27]
  v_mfma_f32_16x16x16_bf16 v[28:31], v[208:209], a[50:51], v[28:31]
  v_mfma_f32_16x16x16_bf16 v[24:27], v[210:211], a[52:53], v[24:27]
  v_mfma_f32_16x16x16_bf16 v[28:31], v[210:211], a[54:55], v[28:31]
  v_mfma_f32_16x16x16_bf16 v[24:27], v[212:213], a[56:57], v[24:27]
  v_mfma_f32_16x16x16_bf16 v[28:31], v[212:213], a[58:59], v[28:31]
  v_mfma_f32_16x16x16_bf16 v[24:27], v[214:215], a[60:61], v[24:27]
  v_mfma_f32_16x16x16_bf16 v[28:31], v[214:215], a[62:63], v[28:31]
  buffer_load_dwordx4 a[32:35], v248, s[24:27], s61 offen offset:0 nt
  buffer_load_dwordx4 a[36:39], v249, s[24:27], s61 offen offset:64 nt
  buffer_load_dwordx4 a[40:43], v250, s[24:27], s61 offen offset:128 nt
  buffer_load_dwordx4 a[44:47], v251, s[24:27], s61 offen offset:192 nt
  buffer_load_dwordx4 a[48:51], v248, s[24:27], s39 offen offset:0 nt
  buffer_load_dwordx4 a[52:55], v249, s[24:27], s39 offen offset:64 nt
  buffer_load_dwordx4 a[56:59], v250, s[24:27], s39 offen offset:128 nt
  buffer_load_dwordx4 a[60:63], v251, s[24:27], s39 offen offset:192 nt
  s_add_u32 s96, s96, 65536
  s_xor_b32 s61, s96, s97
  s_add_u32 s39, s61, 0x1000
  v_fma_f32 v192, v192, s40, -v61
  v_fma_f32 v193, v193, s40, -v61
  v_fma_f32 v194, v194, s40, -v61
  v_fma_f32 v195, v195, s40, -v61
  v_fma_f32 v196, v196, s40, -v61
  v_fma_f32 v197, v197, s40, -v61
  v_fma_f32 v198, v198, s40, -v61
  v_fma_f32 v199, v199, s40, -v61
  v_exp_f32 v192, v192
  v_exp_f32 v193, v193
  v_exp_f32 v194, v194
  v_exp_f32 v195, v195
  v_exp_f32 v196, v196
  v_exp_f32 v197, v197
  v_exp_f32 v198, v198
  v_exp_f32 v199, v199
  v_add_f32 v6, v192, v193
  v_add_f32 v7, v194, v195
  v_add_f32 v62, v62, v6
  v_add_f32 v6, v196, v197
  v_add_f32 v62, v62, v7
  v_add_f32 v7, v198, v199
  v_add_f32 v62, v62, v6
  v_add_f32 v62, v62, v7
  v_cvt_pk_bf16_f32 v192, v192, v193
  v_cvt_pk_bf16_f32 v193, v194, v195
  v_cvt_pk_bf16_f32 v194, v196, v197
  v_cvt_pk_bf16_f32 v195, v198, v199
  v_perm_b32 v200, v192, v192, v56
  v_perm_b32 v201, v192, v192, v57
  v_perm_b32 v202, v192, v192, v58
  v_perm_b32 v203, v192, v192, v59
  v_perm_b32 v204, v193, v193, v56
  v_perm_b32 v205, v193, v193, v57
  v_perm_b32 v206, v193, v193, v58
  v_perm_b32 v207, v193, v193, v59
  v_perm_b32 v208, v194, v194, v56
  v_perm_b32 v209, v194, v194, v57
  v_perm_b32 v210, v194, v194, v58
  v_perm_b32 v211, v194, v194, v59
  v_perm_b32 v212, v195, v195, v56
  v_perm_b32 v213, v195, v195, v57
  v_perm_b32 v214, v195, v195, v58
  v_perm_b32 v215, v195, v195, v59
  ds_read_b128 v[32:35], v236 offset:10240
  ds_read_b128 v[36:39], v236 offset:10496
  ds_read_b128 v[192:195], v236 offset:10752
  ds_read_b128 v[196:199], v236 offset:11008
  s_waitcnt vmcnt(24)
  s_memrealtime s[50:51]
  ds_read_b32 v81, v80
  s_cmp_lg_u32 s54, 0
  s_cbranch_scc1 L_qa3
  v_mfma_f32_16x16x16_bf16 v[220:223], v[40:41], a[64:65], v[220:223]
  v_mfma_f32_16x16x16_bf16 v[224:227], v[40:41], a[66:67], v[224:227]
  v_mfma_f32_16x16x16_bf16 v[228:231], v[42:43], a[64:65], v[228:231]
  v_mfma_f32_16x16x16_bf16 v[232:235], v[42:43], a[66:67], v[232:235]
  v_mfma_f32_16x16x16_bf16 v[220:223], v[42:43], a[68:69], v[220:223]
  v_mfma_f32_16x16x16_bf16 v[224:227], v[42:43], a[70:71], v[224:227]
  v_mfma_f32_16x16x16_bf16 v[228:231], v[40:41], a[68:69], v[228:231]
  v_mfma_f32_16x16x16_bf16 v[232:235], v[40:41], a[70:71], v[232:235]
  v_mfma_f32_16x16x16_bf16 v[220:223], v[44:45], a[72:73], v[220:223]
  v_mfma_f32_16x16x16_bf16 v[224:227], v[44:45], a[74:75], v[224:227]
  v_mfma_f32_16x16x16_bf16 v[228:231], v[46:47], a[72:73], v[228:231]
  v_mfma_f32_16x16x16_bf16 v[232:235], v[46:47], a[74:75], v[232:235]
  v_mfma_f32_16x16x16_bf16 v[220:223], v[46:47], a[76:77], v[220:223]
  v_mfma_f32_16x16x16_bf16 v[224:227], v[46:47], a[78:79], v[224:227]
  v_mfma_f32_16x16x16_bf16 v[228:231], v[44:45], a[76:77], v[228:231]
  v_mfma_f32_16x16x16_bf16 v[232:235], v[44:45], a[78:79], v[232:235]
  v_mfma_f32_16x16x16_bf16 v[220:223], v[48:49], a[80:81], v[220:223]
  v_mfma_f32_16x16x16_bf16 v[224:227], v[48:49], a[82:83], v[224:227]
  v_mfma_f32_16x16x16_bf16 v[228:231], v[50:51], a[80:81], v[228:231]
  v_mfma_f32_16x16x16_bf16 v[232:235], v[50:51], a[82:83], v[232:235]
  v_mfma_f32_16x16x16_bf16 v[220:223], v[50:51], a[84:85], v[220:223]
  v_mfma_f32_16x16x16_bf16 v[224:227], v[50:51], a[86:87], v[224:227]
  v_mfma_f32_16x16x16_bf16 v[228:231], v[48:49], a[84:85], v[228:231]
  v_mfma_f32_16x16x16_bf16 v[232:235], v[48:49], a[86:87], v[232:235]
  v_mfma_f32_16x16x16_bf16 v[220:223], v[52:53], a[88:89], v[220:223]
  v_mfma_f32_16x16x16_bf16 v[224:227], v[52:53], a[90:91], v[224:227]
  v_mfma_f32_16x16x16_bf16 v[228:231], v[54:55], a[88:89], v[228:231]
  v_mfma_f32_16x16x16_bf16 v[232:235], v[54:55], a[90:91], v[232:235]
  v_mfma_f32_16x16x16_bf16 v[220:223], v[54:55], a[92:93], v[220:223]
  v_mfma_f32_16x16x16_bf16 v[224:227], v[54:55], a[94:95], v[224:227]
  v_mfma_f32_16x16x16_bf16 v[228:231], v[52:53], a[92:93], v[228:231]
  v_mfma_f32_16x16x16_bf16 v[232:235], v[52:53], a[94:95], v[232:235]
  s_branch L_qb3
L_qa3:
  v_mfma_f32_16x16x16_bf16 v[24:27], v[40:41], a[64:65], v[24:27]
  v_mfma_f32_16x16x16_bf16 v[28:31], v[40:41], a[66:67], v[28:31]
  v_mfma_f32_16x16x16_bf16 v[24:27], v[42:43], a[68:69], v[24:27]
  v_mfma_f32_16x16x16_bf16 v[28:31], v[42:43], a[70:71], v[28:31]
  v_mfma_f32_16x16x16_bf16 v[24:27], v[44:45], a[72:73], v[24:27]
  v_mfma_f32_16x16x16_bf16 v[28:31], v[44:45], a[74:75], v[28:31]
  v_mfma_f32_16x16x16_bf16 v[24:27], v[46:47], a[76:77], v[24:27]
  v_mfma_f32_16x16x16_bf16 v[28:31], v[46:47], a[78:79], v[28:31]
  v_mfma_f32_16x16x16_bf16 v[24:27], v[48:49], a[80:81], v[24:27]
  v_mfma_f32_16x16x16_bf16 v[28:31], v[48:49], a[82:83], v[28:31]
  v_mfma_f32_16x16x16_bf16 v[24:27], v[50:51], a[84:85], v[24:27]
  v_mfma_f32_16x16x16_bf16 v[28:31], v[50:51], a[86:87], v[28:31]
  v_mfma_f32_16x16x16_bf16 v[24:27], v[52:53], a[88:89], v[24:27]
  v_mfma_f32_16x16x16_bf16 v[28:31], v[52:53], a[90:91], v[28:31]
  v_mfma_f32_16x16x16_bf16 v[24:27], v[54:55], a[92:93], v[24:27]
  v_mfma_f32_16x16x16_bf16 v[28:31], v[54:55], a[94:95], v[28:31]
L_qb3:
  s_waitcnt lgkmcnt(0)
  v_readfirstlane_b32 s41, v81
  v_add_u32 v80, 4, v80
  s_sub_u32 s41, s50, s41
  s_cmp_gt_i32 s41, 0
  s_cselect_b64 s[54:55], s[68:69], 0
  v_cndmask_b32 v76, v216, v72, s[54:55]
  v_cndmask_b32 v77, v217, v73, s[54:55]
  v_cndmask_b32 v78, v218, v74, s[54:55]
  v_cndmask_b32 v79, v219, v75, s[54:55]
  buffer_load_dwordx4 a[64:67], v76, s[24:27], s61 offen offset:0 nt
  buffer_load_dwordx4 a[68:71], v77, s[24:27], s61 offen offset:64 nt
  buffer_load_dwordx4 a[72:75], v78, s[24:27], s61 offen offset:128 nt
  buffer_load_dwordx4 a[76:79], v79, s[24:27], s61 offen offset:192 nt
  buffer_load_dwordx4 a[80:83], v76, s[24:27], s39 offen offset:0 nt
  buffer_load_dwordx4 a[84:87], v77, s[24:27], s39 offen offset:64 nt
  buffer_load_dwordx4 a[88:91], v78, s[24:27], s39 offen offset:128 nt
  buffer_load_dwordx4 a[92:95], v79, s[24:27], s39 offen offset:192 nt
  s_add_u32 s96, s96, 65536
  s_xor_b32 s61, s96, s97
  s_add_u32 s39, s61, 0x1000
  v_fma_f32 v32, v32, s40, -v61
  v_fma_f32 v33, v33, s40, -v61
  v_fma_f32 v34, v34, s40, -v61
  v_fma_f32 v35, v35, s40, -v61
  v_fma_f32 v36, v36, s40, -v61
  v_fma_f32 v37, v37, s40, -v61
  v_fma_f32 v38, v38, s40, -v61
  v_fma_f32 v39, v39, s40, -v61
  v_exp_f32 v32, v32
  v_exp_f32 v33, v33
  v_exp_f32 v34, v34
  v_exp_f32 v35, v35
  v_exp_f32 v36, v36
  v_exp_f32 v37, v37
  v_exp_f32 v38, v38
  v_exp_f32 v39, v39
  v_add_f32 v6, v32, v33
  v_add_f32 v7, v34, v35
  v_add_f32 v62, v62, v6
  v_add_f32 v6, v36, v37
  v_add_f32 v62, v62, v7
  v_add_f32 v7, v38, v39
  v_add_f32 v62, v62, v6
  v_add_f32 v62, v62, v7
  v_cvt_pk_bf16_f32 v32, v32, v33
  v_cvt_pk_bf16_f32 v33, v34, v35
  v_cvt_pk_bf16_f32 v34, v36, v37
  v_cvt_pk_bf16_f32 v35, v38, v39
  v_perm_b32 v40, v32, v32, v56
  v_perm_b32 v41, v32, v32, v57
  v_perm_b32 v42, v32, v32, v58
  v_perm_b32 v43, v32, v32, v59
  v_perm_b32 v44, v33, v33, v56
  v_perm_b32 v45, v33, v33, v57
  v_perm_b32 v46, v33, v33, v58
  v_perm_b32 v47, v33, v33, v59
  v_perm_b32 v48, v34, v34, v56
  v_perm_b32 v49, v34, v34, v57
  v_perm_b32 v50, v34, v34, v58
  v_perm_b32 v51, v34, v34, v59
  v_perm_b32 v52, v35, v35, v56
  v_perm_b32 v53, v35, v35, v57
  v_perm_b32 v54, v35, v35, v58
  v_perm_b32 v55, v35, v35, v59
  s_waitcnt vmcnt(24)
  v_mfma_f32_16x16x16_bf16 v[24:27], v[200:201], a[96:97], v[24:27]
  v_mfma_f32_16x16x16_bf16 v[28:31], v[200:201], a[98:99], v[28:31]
  v_mfma_f32_16x16x16_bf16 v[24:27], v[202:203], a[100:101], v[24:27]
  v_mfma_f32_16x16x16_bf16 v[28:31], v[202:203], a[102:103], v[28:31]
  v_mfma_f32_16x16x16_bf16 v[24:27], v[204:205], a[104:105], v[24:27]
  v_mfma_f32_16x16x16_bf16 v[28:31], v[204:205], a[106:107], v[28:31]
  v_mfma_f32_16x16x16_bf16 v[24:27], v[206:207], a[108:109], v[24:27]
  v_mfma_f32_16x16x16_bf16 v[28:31], v[206:207], a[110:111], v[28:31]
  v_mfma_f32_16x16x16_bf16 v[24:27], v[208:209], a[112:113], v[24:27]
  v_mfma_f32_16x16x16_bf16 v[28:31], v[208:209], a[114:115], v[28:31]
  v_mfma_f32_16x16x16_bf16 v[24:27], v[210:211], a[116:117], v[24:27]
  v_mfma_f32_16x16x16_bf16 v[28:31], v[210:211], a[118:119], v[28:31]
  v_mfma_f32_16x16x16_bf16 v[24:27], v[212:213], a[120:121], v[24:27]
  v_mfma_f32_16x16x16_bf16 v[28:31], v[212:213], a[122:123], v[28:31]
  v_mfma_f32_16x16x16_bf16 v[24:27], v[214:215], a[124:125], v[24:27]
  v_mfma_f32_16x16x16_bf16 v[28:31], v[214:215], a[126:127], v[28:31]
  buffer_load_dwordx4 a[96:99], v248, s[24:27], s61 offen offset:0 nt
  buffer_load_dwordx4 a[100:103], v249, s[24:27], s61 offen offset:64 nt
  buffer_load_dwordx4 a[104:107], v250, s[24:27], s61 offen offset:128 nt
  buffer_load_dwordx4 a[108:111], v251, s[24:27], s61 offen offset:192 nt
  buffer_load_dwordx4 a[112:115], v248, s[24:27], s39 offen offset:0 nt
  buffer_load_dwordx4 a[116:119], v249, s[24:27], s39 offen offset:64 nt
  buffer_load_dwordx4 a[120:123], v250, s[24:27], s39 offen offset:128 nt
  buffer_load_dwordx4 a[124:127], v251, s[24:27], s39 offen offset:192 nt
  s_add_u32 s96, s96, 65536
  s_xor_b32 s61, s96, s97
  s_add_u32 s39, s61, 0x1000
  v_fma_f32 v192, v192, s40, -v61
  v_fma_f32 v193, v193, s40, -v61
  v_fma_f32 v194, v194, s40, -v61
  v_fma_f32 v195, v195, s40, -v61
  v_fma_f32 v196, v196, s40, -v61
  v_fma_f32 v197, v197, s40, -v61
  v_fma_f32 v198, v198, s40, -v61
  v_fma_f32 v199, v199, s40, -v61
  v_exp_f32 v192, v192
  v_exp_f32 v193, v193
  v_exp_f32 v194, v194
  v_exp_f32 v195, v195
  v_exp_f32 v196, v196
  v_exp_f32 v197, v197
  v_exp_f32 v198, v198
  v_exp_f32 v199, v199
  v_add_f32 v6, v192, v193
  v_add_f32 v7, v194, v195
  v_add_f32 v62, v62, v6
  v_add_f32 v6, v196, v197
  v_add_f32 v62, v62, v7
  v_add_f32 v7, v198, v199
  v_add_f32 v62, v62, v6
  v_add_f32 v62, v62, v7
  v_cvt_pk_bf16_f32 v192, v192, v193
  v_cvt_pk_bf16_f32 v193, v194, v195
  v_cvt_pk_bf16_f32 v194, v196, v197
  v_cvt_pk_bf16_f32 v195, v198, v199
  v_perm_b32 v200, v192, v192, v56
  v_perm_b32 v201, v192, v192, v57
  v_perm_b32 v202, v192, v192, v58
  v_perm_b32 v203, v192, v192, v59
  v_perm_b32 v204, v193, v193, v56
  v_perm_b32 v205, v193, v193, v57
  v_perm_b32 v206, v193, v193, v58
  v_perm_b32 v207, v193, v193, v59
  v_perm_b32 v208, v194, v194, v56
  v_perm_b32 v209, v194, v194, v57
  v_perm_b32 v210, v194, v194, v58
  v_perm_b32 v211, v194, v194, v59
  v_perm_b32 v212, v195, v195, v56
  v_perm_b32 v213, v195, v195, v57
  v_perm_b32 v214, v195, v195, v58
  v_perm_b32 v215, v195, v195, v59
  s_bitcmp0_b32 s70, s60
  s_cbranch_scc1 L_vl_nb
  s_barrier
  s_mov_b64 s[68:69], -1
L_vl_nb:
  v_add_u32 v236, 2048, v236
  s_add_u32 s60, s60, 1
  s_cmp_lt_u32 s60, 15
  s_cbranch_scc1 L_vl
  ds_read_b32 v123, v147 offset:4360
  ds_read_b32 v127, v147 offset:4360
  ds_read_b32 v131, v147 offset:4360
  ds_read_b32 v87, v146 offset:4368
  ds_read_b64 v[92:93], v83 offset:4112
  ds_read_b128 v[96:99], v4 offset:5120
  ds_read_b128 v[100:103], v4 offset:6144
  ds_read_b128 v[32:35], v236 offset:9216
  ds_read_b128 v[36:39], v236 offset:9472
  ds_read_b128 v[192:195], v236 offset:9728
  ds_read_b128 v[196:199], v236 offset:9984
  s_waitcnt vmcnt(24)
  s_cmp_lg_u32 s52, 0
  s_cbranch_scc1 L_qa4
  v_mfma_f32_16x16x16_bf16 v[220:223], v[40:41], a[0:1], v[220:223]
  v_mfma_f32_16x16x16_bf16 v[224:227], v[40:41], a[2:3], v[224:227]
  v_mfma_f32_16x16x16_bf16 v[228:231], v[42:43], a[0:1], v[228:231]
  v_mfma_f32_16x16x16_bf16 v[232:235], v[42:43], a[2:3], v[232:235]
  v_mfma_f32_16x16x16_bf16 v[220:223], v[42:43], a[4:5], v[220:223]
  v_mfma_f32_16x16x16_bf16 v[224:227], v[42:43], a[6:7], v[224:227]
  v_mfma_f32_16x16x16_bf16 v[228:231], v[40:41], a[4:5], v[228:231]
  v_mfma_f32_16x16x16_bf16 v[232:235], v[40:41], a[6:7], v[232:235]
  v_mfma_f32_16x16x16_bf16 v[220:223], v[44:45], a[8:9], v[220:223]
  v_mfma_f32_16x16x16_bf16 v[224:227], v[44:45], a[10:11], v[224:227]
  v_mfma_f32_16x16x16_bf16 v[228:231], v[46:47], a[8:9], v[228:231]
  v_mfma_f32_16x16x16_bf16 v[232:235], v[46:47], a[10:11], v[232:235]
  v_mfma_f32_16x16x16_bf16 v[220:223], v[46:47], a[12:13], v[220:223]
  v_mfma_f32_16x16x16_bf16 v[224:227], v[46:47], a[14:15], v[224:227]
  v_mfma_f32_16x16x16_bf16 v[228:231], v[44:45], a[12:13], v[228:231]
  v_mfma_f32_16x16x16_bf16 v[232:235], v[44:45], a[14:15], v[232:235]
  v_mfma_f32_16x16x16_bf16 v[220:223], v[48:49], a[16:17], v[220:223]
  v_mfma_f32_16x16x16_bf16 v[224:227], v[48:49], a[18:19], v[224:227]
  v_mfma_f32_16x16x16_bf16 v[228:231], v[50:51], a[16:17], v[228:231]
  v_mfma_f32_16x16x16_bf16 v[232:235], v[50:51], a[18:19], v[232:235]
  v_mfma_f32_16x16x16_bf16 v[220:223], v[50:51], a[20:21], v[220:223]
  v_mfma_f32_16x16x16_bf16 v[224:227], v[50:51], a[22:23], v[224:227]
  v_mfma_f32_16x16x16_bf16 v[228:231], v[48:49], a[20:21], v[228:231]
  v_mfma_f32_16x16x16_bf16 v[232:235], v[48:49], a[22:23], v[232:235]
  v_mfma_f32_16x16x16_bf16 v[220:223], v[52:53], a[24:25], v[220:223]
  v_mfma_f32_16x16x16_bf16 v[224:227], v[52:53], a[26:27], v[224:227]
  v_mfma_f32_16x16x16_bf16 v[228:231], v[54:55], a[24:25], v[228:231]
  v_mfma_f32_16x16x16_bf16 v[232:235], v[54:55], a[26:27], v[232:235]
  v_mfma_f32_16x16x16_bf16 v[220:223], v[54:55], a[28:29], v[220:223]
  v_mfma_f32_16x16x16_bf16 v[224:227], v[54:55], a[30:31], v[224:227]
  v_mfma_f32_16x16x16_bf16 v[228:231], v[52:53], a[28:29], v[228:231]
  v_mfma_f32_16x16x16_bf16 v[232:235], v[52:53], a[30:31], v[232:235]
  s_branch L_qb4
L_qa4:
  v_mfma_f32_16x16x16_bf16 v[24:27], v[40:41], a[0:1], v[24:27]
  v_mfma_f32_16x16x16_bf16 v[28:31], v[40:41], a[2:3], v[28:31]
  v_mfma_f32_16x16x16_bf16 v[24:27], v[42:43], a[4:5], v[24:27]
  v_mfma_f32_16x16x16_bf16 v[28:31], v[42:43], a[6:7], v[28:31]
  v_mfma_f32_16x16x16_bf16 v[24:27], v[44:45], a[8:9], v[24:27]
  v_mfma_f32_16x16x16_bf16 v[28:31], v[44:45], a[10:11], v[28:31]
  v_mfma_f32_16x16x16_bf16 v[24:27], v[46:47], a[12:13], v[24:27]
  v_mfma_f32_16x16x16_bf16 v[28:31], v[46:47], a[14:15], v[28:31]
  v_mfma_f32_16x16x16_bf16 v[24:27], v[48:49], a[16:17], v[24:27]
  v_mfma_f32_16x16x16_bf16 v[28:31], v[48:49], a[18:19], v[28:31]
  v_mfma_f32_16x16x16_bf16 v[24:27], v[50:51], a[20:21], v[24:27]
  v_mfma_f32_16x16x16_bf16 v[28:31], v[50:51], a[22:23], v[28:31]
  v_mfma_f32_16x16x16_bf16 v[24:27], v[52:53], a[24:25], v[24:27]
  v_mfma_f32_16x16x16_bf16 v[28:31], v[52:53], a[26:27], v[28:31]
  v_mfma_f32_16x16x16_bf16 v[24:27], v[54:55], a[28:29], v[24:27]
  v_mfma_f32_16x16x16_bf16 v[28:31], v[54:55], a[30:31], v[28:31]
L_qb4:
  s_waitcnt lgkmcnt(0)
  v_fma_f32 v32, v32, s40, -v61
  v_fma_f32 v33, v33, s40, -v61
  v_fma_f32 v34, v34, s40, -v61
  v_fma_f32 v35, v35, s40, -v61
  v_fma_f32 v36, v36, s40, -v61
  v_fma_f32 v37, v37, s40, -v61
  v_fma_f32 v38, v38, s40, -v61
  v_fma_f32 v39, v39, s40, -v61
  v_exp_f32 v32, v32
  v_exp_f32 v33, v33
  v_exp_f32 v34, v34
  v_exp_f32 v35, v35
  v_exp_f32 v36, v36
  v_exp_f32 v37, v37
  v_exp_f32 v38, v38
  v_exp_f32 v39, v39
  v_add_f32 v6, v32, v33
  v_add_f32 v7, v34, v35
  v_add_f32 v62, v62, v6
  v_add_f32 v6, v36, v37
  v_add_f32 v62, v62, v7
  v_add_f32 v7, v38, v39
  v_add_f32 v62, v62, v6
  v_add_f32 v62, v62, v7
  v_cvt_pk_bf16_f32 v32, v32, v33
  v_cvt_pk_bf16_f32 v33, v34, v35
  v_cvt_pk_bf16_f32 v34, v36, v37
  v_cvt_pk_bf16_f32 v35, v38, v39
  v_perm_b32 v40, v32, v32, v56
  v_perm_b32 v41, v32, v32, v57
  v_perm_b32 v42, v32, v32, v58
  v_perm_b32 v43, v32, v32, v59
  v_perm_b32 v44, v33, v33, v56
  v_perm_b32 v45, v33, v33, v57
  v_perm_b32 v46, v33, v33, v58
  v_perm_b32 v47, v33, v33, v59
  v_perm_b32 v48, v34, v34, v56
  v_perm_b32 v49, v34, v34, v57
  v_perm_b32 v50, v34, v34, v58
  v_perm_b32 v51, v34, v34, v59
  v_perm_b32 v52, v35, v35, v56
  v_perm_b32 v53, v35, v35, v57
  v_perm_b32 v54, v35, v35, v58
  v_perm_b32 v55, v35, v35, v59
  s_waitcnt vmcnt(16)
  v_mfma_f32_16x16x16_bf16 v[24:27], v[200:201], a[32:33], v[24:27]
  v_mfma_f32_16x16x16_bf16 v[28:31], v[200:201], a[34:35], v[28:31]
  v_mfma_f32_16x16x16_bf16 v[24:27], v[202:203], a[36:37], v[24:27]
  v_mfma_f32_16x16x16_bf16 v[28:31], v[202:203], a[38:39], v[28:31]
  v_mfma_f32_16x16x16_bf16 v[24:27], v[204:205], a[40:41], v[24:27]
  v_mfma_f32_16x16x16_bf16 v[28:31], v[204:205], a[42:43], v[28:31]
  v_mfma_f32_16x16x16_bf16 v[24:27], v[206:207], a[44:45], v[24:27]
  v_mfma_f32_16x16x16_bf16 v[28:31], v[206:207], a[46:47], v[28:31]
  v_mfma_f32_16x16x16_bf16 v[24:27], v[208:209], a[48:49], v[24:27]
  v_mfma_f32_16x16x16_bf16 v[28:31], v[208:209], a[50:51], v[28:31]
  v_mfma_f32_16x16x16_bf16 v[24:27], v[210:211], a[52:53], v[24:27]
  v_mfma_f32_16x16x16_bf16 v[28:31], v[210:211], a[54:55], v[28:31]
  v_mfma_f32_16x16x16_bf16 v[24:27], v[212:213], a[56:57], v[24:27]
  v_mfma_f32_16x16x16_bf16 v[28:31], v[212:213], a[58:59], v[28:31]
  v_mfma_f32_16x16x16_bf16 v[24:27], v[214:215], a[60:61], v[24:27]
  v_mfma_f32_16x16x16_bf16 v[28:31], v[214:215], a[62:63], v[28:31]
  v_fma_f32 v192, v192, s40, -v61
  v_fma_f32 v193, v193, s40, -v61
  v_fma_f32 v194, v194, s40, -v61
  v_fma_f32 v195, v195, s40, -v61
  v_fma_f32 v196, v196, s40, -v61
  v_fma_f32 v197, v197, s40, -v61
  v_fma_f32 v198, v198, s40, -v61
  v_fma_f32 v199, v199, s40, -v61
  v_exp_f32 v192, v192
  v_exp_f32 v193, v193
  v_exp_f32 v194, v194
  v_exp_f32 v195, v195
  v_exp_f32 v196, v196
  v_exp_f32 v197, v197
  v_exp_f32 v198, v198
  v_exp_f32 v199, v199
  v_add_f32 v6, v192, v193
  v_add_f32 v7, v194, v195
  v_add_f32 v62, v62, v6
  v_add_f32 v6, v196, v197
  v_add_f32 v62, v62, v7
  v_add_f32 v7, v198, v199
  v_add_f32 v62, v62, v6
  v_add_f32 v62, v62, v7
  v_cvt_pk_bf16_f32 v192, v192, v193
  v_cvt_pk_bf16_f32 v193, v194, v195
  v_cvt_pk_bf16_f32 v194, v196, v197
  v_cvt_pk_bf16_f32 v195, v198, v199
  v_perm_b32 v200, v192, v192, v56
  v_perm_b32 v201, v192, v192, v57
  v_perm_b32 v202, v192, v192, v58
  v_perm_b32 v203, v192, v192, v59
  v_perm_b32 v204, v193, v193, v56
  v_perm_b32 v205, v193, v193, v57
  v_perm_b32 v206, v193, v193, v58
  v_perm_b32 v207, v193, v193, v59
  v_perm_b32 v208, v194, v194, v56
  v_perm_b32 v209, v194, v194, v57
  v_perm_b32 v210, v194, v194, v58
  v_perm_b32 v211, v194, v194, v59
  v_perm_b32 v212, v195, v195, v56
  v_perm_b32 v213, v195, v195, v57
  v_perm_b32 v214, v195, v195, v58
  v_perm_b32 v215, v195, v195, v59
  v_readfirstlane_b32 s81, v87
  v_mov_b32 v7, v62
  s_nop 1
  v_permlane32_swap_b32 v62, v7
  v_add_f32 v62, v62, v7
  v_mov_b32 v7, v62
  s_nop 1
  v_permlane16_swap_b32 v62, v7
  v_add_f32 v63, v62, v7
  v_mov_b32 v62, v61
  s_mov_b64 exec, s[90:91]
  ds_write_b64 v3, v[62:63] offset:4096
  s_mov_b64 exec, s[88:89]
  ds_read_b64 v[88:89], v84 offset:4096
  s_waitcnt vmcnt(8)
  s_cmp_lg_u32 s54, 0
  s_cbranch_scc1 L_qa5
  v_mfma_f32_16x16x16_bf16 v[220:223], v[40:41], a[64:65], v[220:223]
  v_mfma_f32_16x16x16_bf16 v[224:227], v[40:41], a[66:67], v[224:227]
  v_mfma_f32_16x16x16_bf16 v[228:231], v[42:43], a[64:65], v[228:231]
  v_mfma_f32_16x16x16_bf16 v[232:235], v[42:43], a[66:67], v[232:235]
  v_mfma_f32_16x16x16_bf16 v[220:223], v[42:43], a[68:69], v[220:223]
  v_mfma_f32_16x16x16_bf16 v[224:227], v[42:43], a[70:71], v[224:227]
  v_mfma_f32_16x16x16_bf16 v[228:231], v[40:41], a[68:69], v[228:231]
  v_mfma_f32_16x16x16_bf16 v[232:235], v[40:41], a[70:71], v[232:235]
  v_mfma_f32_16x16x16_bf16 v[220:223], v[44:45], a[72:73], v[220:223]
  v_mfma_f32_16x16x16_bf16 v[224:227], v[44:45], a[74:75], v[224:227]
  v_mfma_f32_16x16x16_bf16 v[228:231], v[46:47], a[72:73], v[228:231]
  v_mfma_f32_16x16x16_bf16 v[232:235], v[46:47], a[74:75], v[232:235]
  v_mfma_f32_16x16x16_bf16 v[220:223], v[46:47], a[76:77], v[220:223]
  v_mfma_f32_16x16x16_bf16 v[224:227], v[46:47], a[78:79], v[224:227]
  v_mfma_f32_16x16x16_bf16 v[228:231], v[44:45], a[76:77], v[228:231]
  v_mfma_f32_16x16x16_bf16 v[232:235], v[44:45], a[78:79], v[232:235]
  v_mfma_f32_16x16x16_bf16 v[220:223], v[48:49], a[80:81], v[220:223]
  v_mfma_f32_16x16x16_bf16 v[224:227], v[48:49], a[82:83], v[224:227]
  v_mfma_f32_16x16x16_bf16 v[228:231], v[50:51], a[80:81], v[228:231]
  v_mfma_f32_16x16x16_bf16 v[232:235], v[50:51], a[82:83], v[232:235]
  v_mfma_f32_16x16x16_bf16 v[220:223], v[50:51], a[84:85], v[220:223]
  v_mfma_f32_16x16x16_bf16 v[224:227], v[50:51], a[86:87], v[224:227]
  v_mfma_f32_16x16x16_bf16 v[228:231], v[48:49], a[84:85], v[228:231]
  v_mfma_f32_16x16x16_bf16 v[232:235], v[48:49], a[86:87], v[232:235]
  v_mfma_f32_16x16x16_bf16 v[220:223], v[52:53], a[88:89], v[220:223]
  v_mfma_f32_16x16x16_bf16 v[224:227], v[52:53], a[90:91], v[224:227]
  v_mfma_f32_16x16x16_bf16 v[228:231], v[54:55], a[88:89], v[228:231]
  v_mfma_f32_16x16x16_bf16 v[232:235], v[54:55], a[90:91], v[232:235]
  v_mfma_f32_16x16x16_bf16 v[220:223], v[54:55], a[92:93], v[220:223]
  v_mfma_f32_16x16x16_bf16 v[224:227], v[54:55], a[94:95], v[224:227]
  v_mfma_f32_16x16x16_bf16 v[228:231], v[52:53], a[92:93], v[228:231]
  v_mfma_f32_16x16x16_bf16 v[232:235], v[52:53], a[94:95], v[232:235]
  s_branch L_qb5
L_qa5:
  v_mfma_f32_16x16x16_bf16 v[24:27], v[40:41], a[64:65], v[24:27]
  v_mfma_f32_16x16x16_bf16 v[28:31], v[40:41], a[66:67], v[28:31]
  v_mfma_f32_16x16x16_bf16 v[24:27], v[42:43], a[68:69], v[24:27]
  v_mfma_f32_16x16x16_bf16 v[28:31], v[42:43], a[70:71], v[28:31]
  v_mfma_f32_16x16x16_bf16 v[24:27], v[44:45], a[72:73], v[24:27]
  v_mfma_f32_16x16x16_bf16 v[28:31], v[44:45], a[74:75], v[28:31]
  v_mfma_f32_16x16x16_bf16 v[24:27], v[46:47], a[76:77], v[24:27]
  v_mfma_f32_16x16x16_bf16 v[28:31], v[46:47], a[78:79], v[28:31]
  v_mfma_f32_16x16x16_bf16 v[24:27], v[48:49], a[80:81], v[24:27]
  v_mfma_f32_16x16x16_bf16 v[28:31], v[48:49], a[82:83], v[28:31]
  v_mfma_f32_16x16x16_bf16 v[24:27], v[50:51], a[84:85], v[24:27]
  v_mfma_f32_16x16x16_bf16 v[28:31], v[50:51], a[86:87], v[28:31]
  v_mfma_f32_16x16x16_bf16 v[24:27], v[52:53], a[88:89], v[24:27]
  v_mfma_f32_16x16x16_bf16 v[28:31], v[52:53], a[90:91], v[28:31]
  v_mfma_f32_16x16x16_bf16 v[24:27], v[54:55], a[92:93], v[24:27]
  v_mfma_f32_16x16x16_bf16 v[28:31], v[54:55], a[94:95], v[28:31]
L_qb5:
  ds_read_b64 v[90:91], v85 offset:4096
  s_nop 6
  v_cndmask_b32 v220, v220, v228, s[10:11]
  v_cndmask_b32 v221, v221, v229, s[10:11]
  v_cndmask_b32 v222, v222, v230, s[10:11]
  v_cndmask_b32 v223, v223, v231, s[10:11]
  v_cndmask_b32 v224, v224, v232, s[10:11]
  v_cndmask_b32 v225, v225, v233, s[10:11]
  v_cndmask_b32 v226, v226, v234, s[10:11]
  v_cndmask_b32 v227, v227, v235, s[10:11]
  v_pk_add_f32 v[24:25], v[24:25], v[220:221]
  v_pk_add_f32 v[26:27], v[26:27], v[222:223]
  v_pk_add_f32 v[28:29], v[28:29], v[224:225]
  v_pk_add_f32 v[30:31], v[30:31], v[226:227]
  s_nop 1
  s_waitcnt vmcnt(7)
  v_mfma_f32_16x16x16_bf16 v[24:27], v[200:201], a[96:97], v[24:27]
  v_mfma_f32_16x16x16_bf16 v[28:31], v[200:201], a[98:99], v[28:31]
  s_waitcnt lgkmcnt(0)
  v_max3_f32 v144, v88, v92, v90
  v_sub_f32 v184, v88, v144
  v_sub_f32 v186, v92, v144
  v_sub_f32 v188, v90, v144
  v_exp_f32 v184, v184
  v_exp_f32 v186, v186
  v_exp_f32 v188, v188
  s_nop 0
  v_mul_f32 v145, v184, v89
  v_fmac_f32 v145, v186, v93
  v_fmac_f32 v145, v188, v91
  v_pk_mul_f32 v[120:121], v[96:97], v[186:187] op_sel_hi:[1,0]
  v_pk_mul_f32 v[124:125], v[98:99], v[186:187] op_sel_hi:[1,0]
  v_pk_mul_f32 v[128:129], v[100:101], v[186:187] op_sel_hi:[1,0]
  v_mul_f32 v122, v102, v186
  v_mul_f32 v126, v103, v186
  v_cndmask_b32 v130, v144, v145, vcc
  v_cmp_o_f32 s[18:19], v145, v145
  s_cmp_eq_u64 s[18:19], -1
  s_cselect_b32 s67, 1, 7
  s_cmp_lg_u32 s74, 0
  s_cbranch_scc1 L_uc
  s_waitcnt vmcnt(6)
  v_mfma_f32_16x16x16_bf16 v[24:27], v[202:203], a[100:101], v[24:27]
  v_mfma_f32_16x16x16_bf16 v[28:31], v[202:203], a[102:103], v[28:31]
  s_waitcnt vmcnt(5)
  v_mfma_f32_16x16x16_bf16 v[24:27], v[204:205], a[104:105], v[24:27]
  v_mfma_f32_16x16x16_bf16 v[28:31], v[204:205], a[106:107], v[28:31]
  s_waitcnt vmcnt(4)
  v_mfma_f32_16x16x16_bf16 v[24:27], v[206:207], a[108:109], v[24:27]
  v_mfma_f32_16x16x16_bf16 v[28:31], v[206:207], a[110:111], v[28:31]
  s_waitcnt vmcnt(3)
  v_mfma_f32_16x16x16_bf16 v[24:27], v[208:209], a[112:113], v[24:27]
  v_mfma_f32_16x16x16_bf16 v[28:31], v[208:209], a[114:115], v[28:31]
  s_waitcnt vmcnt(2)
  v_mfma_f32_16x16x16_bf16 v[24:27], v[210:211], a[116:117], v[24:27]
  v_mfma_f32_16x16x16_bf16 v[28:31], v[210:211], a[118:119], v[28:31]
  s_waitcnt vmcnt(1)
  v_mfma_f32_16x16x16_bf16 v[24:27], v[212:213], a[120:121], v[24:27]
  v_mfma_f32_16x16x16_bf16 v[28:31], v[212:213], a[122:123], v[28:31]
  s_waitcnt vmcnt(0)
  v_mfma_f32_16x16x16_bf16 v[24:27], v[214:215], a[124:125], v[24:27]
  v_mfma_f32_16x16x16_bf16 v[28:31], v[214:215], a[126:127], v[28:31]
  ds_read_b32 v87, v146 offset:4352
  ds_read_b128 v[104:107], v82
  ds_read_b128 v[108:111], v82 offset:1024
  s_waitcnt lgkmcnt(2)
  v_readfirstlane_b32 s41, v87
  s_cmp_eq_u32 s41, s67
  s_cbranch_scc0 L_uslow
  s_waitcnt lgkmcnt(0)
L_ufp:
  s_cmp_eq_u32 s81, 1
  v_pk_fma_f32 v[120:121], v[104:105], v[188:189], v[120:121] op_sel_hi:[1,0,1]
  v_pk_fma_f32 v[124:125], v[106:107], v[188:189], v[124:125] op_sel_hi:[1,0,1]
  v_pk_fma_f32 v[128:129], v[108:109], v[188:189], v[128:129] op_sel_hi:[1,0,1]
  v_fmac_f32 v122, v110, v188
  v_fmac_f32 v126, v111, v188
  v_pk_fma_f32 v[120:121], v[24:25], v[184:185], v[120:121] op_sel_hi:[1,0,1]
  v_pk_fma_f32 v[124:125], v[26:27], v[184:185], v[124:125] op_sel_hi:[1,0,1]
  v_pk_fma_f32 v[128:129], v[28:29], v[184:185], v[128:129] op_sel_hi:[1,0,1]
  v_fmac_f32 v122, v30, v184
  v_fmac_f32 v126, v31, v184
  s_cbranch_scc0 L_pubfar
  buffer_store_dwordx4 v[120:123], v4, s[44:47], s43 offen offset:0
  buffer_store_dwordx4 v[124:127], v4, s[44:47], s43 offen offset:1024
  buffer_store_dwordx4 v[128:131], v4, s[44:47], s43 offen offset:2048
  s_endpgm
L_uc:
  s_waitcnt vmcnt(6)
  v_mfma_f32_16x16x16_bf16 v[24:27], v[202:203], a[100:101], v[24:27]
  v_mfma_f32_16x16x16_bf16 v[28:31], v[202:203], a[102:103], v[28:31]
  s_waitcnt vmcnt(5)
  v_mfma_f32_16x16x16_bf16 v[24:27], v[204:205], a[104:105], v[24:27]
  v_mfma_f32_16x16x16_bf16 v[28:31], v[204:205], a[106:107], v[28:31]
  s_waitcnt vmcnt(4)
  v_mfma_f32_16x16x16_bf16 v[24:27], v[206:207], a[108:109], v[24:27]
  v_mfma_f32_16x16x16_bf16 v[28:31], v[206:207], a[110:111], v[28:31]
  buffer_load_dwordx4 v[148:151], v4, s[72:75], s64 offen offset:0 sc1
  buffer_load_dwordx4 v[152:155], v4, s[72:75], s64 offen offset:1024 sc1
  buffer_load_dwordx4 v[156:159], v4, s[72:75], s64 offen offset:2048 sc1
  buffer_load_dwordx4 v[160:163], v4, s[72:75], s65 offen offset:0 sc1
  buffer_load_dwordx4 v[164:167], v4, s[72:75], s65 offen offset:1024 sc1
  buffer_load_dwordx4 v[168:171], v4, s[72:75], s65 offen offset:2048 sc1
  buffer_load_dwordx4 v[172:175], v4, s[72:75], s66 offen offset:0 sc1
  buffer_load_dwordx4 v[176:179], v4, s[72:75], s66 offen offset:1024 sc1
  buffer_load_dwordx4 v[180:183], v4, s[72:75], s66 offen offset:2048 sc1
  s_waitcnt vmcnt(12)
  v_mfma_f32_16x16x16_bf16 v[24:27], v[208:209], a[112:113], v[24:27]
  v_mfma_f32_16x16x16_bf16 v[28:31], v[208:209], a[114:115], v[28:31]
  s_waitcnt vmcnt(11)
  v_mfma_f32_16x16x16_bf16 v[24:27], v[210:211], a[116:117], v[24:27]
  v_mfma_f32_16x16x16_bf16 v[28:31], v[210:211], a[118:119], v[28:31]
  s_waitcnt vmcnt(10)
  v_mfma_f32_16x16x16_bf16 v[24:27], v[212:213], a[120:121], v[24:27]
  v_mfma_f32_16x16x16_bf16 v[28:31], v[212:213], a[122:123], v[28:31]
  s_waitcnt vmcnt(9)
  v_mfma_f32_16x16x16_bf16 v[24:27], v[214:215], a[124:125], v[24:27]
  v_mfma_f32_16x16x16_bf16 v[28:31], v[214:215], a[126:127], v[28:31]
  ds_read_b32 v87, v146 offset:4352
  ds_read_b128 v[104:107], v82
  ds_read_b128 v[108:111], v82 offset:1024
  s_waitcnt lgkmcnt(2)
  v_readfirstlane_b32 s41, v87
  s_cmp_eq_u32 s41, s67
  s_cbranch_scc0 L_uslow
  s_waitcnt lgkmcnt(0)
L_ufc:
  v_pk_fma_f32 v[120:121], v[104:105], v[188:189], v[120:121] op_sel_hi:[1,0,1]
  v_pk_fma_f32 v[124:125], v[106:107], v[188:189], v[124:125] op_sel_hi:[1,0,1]
  v_pk_fma_f32 v[128:129], v[108:109], v[188:189], v[128:129] op_sel_hi:[1,0,1]
  v_fmac_f32 v122, v110, v188
  v_fmac_f32 v126, v111, v188
  v_pk_fma_f32 v[120:121], v[24:25], v[184:185], v[120:121] op_sel_hi:[1,0,1]
  v_pk_fma_f32 v[124:125], v[26:27], v[184:185], v[124:125] op_sel_hi:[1,0,1]
  v_pk_fma_f32 v[128:129], v[28:29], v[184:185], v[128:129] op_sel_hi:[1,0,1]
  v_fmac_f32 v122, v30, v184
  v_fmac_f32 v126, v31, v184
L_poll:
  s_bitcmp1_b32 s79, s76
  s_waitcnt vmcnt(6)
  s_cbranch_scc0 L_pr0
  v_xor_b32 v151, v151, v123
  v_xor_b32 v155, v155, v123
  v_xor_b32 v159, v159, v123
  v_mov_b32_dpp v114, v158 quad_perm:[0,0,2,2] row_mask:0xf bank_mask:0xf
  v_or3_b32 v151, v151, v155, v159
  v_mov_b32_dpp v115, v158 quad_perm:[1,1,3,3] row_mask:0xf bank_mask:0xf
  v_cmp_ne_u32 vcc, 0, v151
  v_max_f32 v116, v144, v114
  s_cbranch_vccnz L_pf0
  v_sub_f32 v112, v144, v116
  v_sub_f32 v114, v114, v116
  v_exp_f32 v112, v112
  v_exp_f32 v114, v114
  v_mov_b32 v144, v116
  s_bitset0_b32 s79, s76
  v_mul_f32 v145, v145, v112
  v_fmac_f32 v145, v114, v115
  v_pk_mul_f32 v[120:121], v[120:121], v[112:113] op_sel_hi:[1,0]
  v_pk_mul_f32 v[124:125], v[124:125], v[112:113] op_sel_hi:[1,0]
  v_pk_mul_f32 v[128:129], v[128:129], v[112:113] op_sel_hi:[1,0]
  v_mul_f32 v122, v122, v112
  v_mul_f32 v126, v126, v112
  v_rcp_f32 v116, v145
  s_cmp_eq_u32 s79, 0
  v_pk_fma_f32 v[120:121], v[148:149], v[114:115], v[120:121] op_sel_hi:[1,0,1]
  v_pk_fma_f32 v[124:125], v[152:153], v[114:115], v[124:125] op_sel_hi:[1,0,1]
  v_pk_fma_f32 v[128:129], v[156:157], v[114:115], v[128:129] op_sel_hi:[1,0,1]
  v_fmac_f32 v122, v150, v114
  v_fmac_f32 v126, v154, v114
  s_cbranch_scc1 L_final
L_pr0:
  s_ff1_i32_b32 s76, s79
  s_lshl_b32 s64, s76, 12
L_pf0:
  buffer_load_dwordx4 v[148:151], v4, s[72:75], s64 offen offset:0 sc1
  buffer_load_dwordx4 v[152:155], v4, s[72:75], s64 offen offset:1024 sc1
  buffer_load_dwordx4 v[156:159], v4, s[72:75], s64 offen offset:2048 sc1
  s_bitcmp1_b32 s79, s77
  s_waitcnt vmcnt(6)
  s_cbranch_scc0 L_pr1
  v_xor_b32 v163, v163, v123
  v_xor_b32 v167, v167, v123
  v_xor_b32 v171, v171, v123
  v_mov_b32_dpp v114, v170 quad_perm:[0,0,2,2] row_mask:0xf bank_mask:0xf
  v_or3_b32 v163, v163, v167, v171
  v_mov_b32_dpp v115, v170 quad_perm:[1,1,3,3] row_mask:0xf bank_mask:0xf
  v_cmp_ne_u32 vcc, 0, v163
  v_max_f32 v116, v144, v114
  s_cbranch_vccnz L_pf1
  v_sub_f32 v112, v144, v116
  v_sub_f32 v114, v114, v116
  v_exp_f32 v112, v112
  v_exp_f32 v114, v114
  v_mov_b32 v144, v116
  s_bitset0_b32 s79, s77
  v_mul_f32 v145, v145, v112
  v_fmac_f32 v145, v114, v115
  v_pk_mul_f32 v[120:121], v[120:121], v[112:113] op_sel_hi:[1,0]
  v_pk_mul_f32 v[124:125], v[124:125], v[112:113] op_sel_hi:[1,0]
  v_pk_mul_f32 v[128:129], v[128:129], v[112:113] op_sel_hi:[1,0]
  v_mul_f32 v122, v122, v112
  v_mul_f32 v126, v126, v112
  v_rcp_f32 v116, v145
  s_cmp_eq_u32 s79, 0
  v_pk_fma_f32 v[120:121], v[160:161], v[114:115], v[120:121] op_sel_hi:[1,0,1]
  v_pk_fma_f32 v[124:125], v[164:165], v[114:115], v[124:125] op_sel_hi:[1,0,1]
  v_pk_fma_f32 v[128:129], v[168:169], v[114:115], v[128:129] op_sel_hi:[1,0,1]
  v_fmac_f32 v122, v162, v114
  v_fmac_f32 v126, v166, v114
  s_cbranch_scc1 L_final
L_pr1:
  s_ff1_i32_b32 s77, s79
  s_lshl_b32 s65, s77, 12
L_pf1:
  buffer_load_dwordx4 v[160:163], v4, s[72:75], s65 offen offset:0 sc1
  buffer_load_dwordx4 v[164:167], v4, s[72:75], s65 offen offset:1024 sc1
  buffer_load_dwordx4 v[168:171], v4, s[72:75], s65 offen offset:2048 sc1
  s_bitcmp1_b32 s79, s78
  s_waitcnt vmcnt(6)
  s_cbranch_scc0 L_pr2
  v_xor_b32 v175, v175, v123
  v_xor_b32 v179, v179, v123
  v_xor_b32 v183, v183, v123
  v_mov_b32_dpp v114, v182 quad_perm:[0,0,2,2] row_mask:0xf bank_mask:0xf
  v_or3_b32 v175, v175, v179, v183
  v_mov_b32_dpp v115, v182 quad_perm:[1,1,3,3] row_mask:0xf bank_mask:0xf
  v_cmp_ne_u32 vcc, 0, v175
  v_max_f32 v116, v144, v114
  s_cbranch_vccnz L_pf2
  v_sub_f32 v112, v144, v116
  v_sub_f32 v114, v114, v116
  v_exp_f32 v112, v112
  v_exp_f32 v114, v114
  v_mov_b32 v144, v116
  s_bitset0_b32 s79, s78
  v_mul_f32 v145, v145, v112
  v_fmac_f32 v145, v114, v115
  v_pk_mul_f32 v[120:121], v[120:121], v[112:113] op_sel_hi:[1,0]
  v_pk_mul_f32 v[124:125], v[124:125], v[112:113] op_sel_hi:[1,0]
  v_pk_mul_f32 v[128:129], v[128:129], v[112:113] op_sel_hi:[1,0]
  v_mul_f32 v122, v122, v112
  v_mul_f32 v126, v126, v112
  v_rcp_f32 v116, v145
  s_cmp_eq_u32 s79, 0
  v_pk_fma_f32 v[120:121], v[172:173], v[114:115], v[120:121] op_sel_hi:[1,0,1]
  v_pk_fma_f32 v[124:125], v[176:177], v[114:115], v[124:125] op_sel_hi:[1,0,1]
  v_pk_fma_f32 v[128:129], v[180:181], v[114:115], v[128:129] op_sel_hi:[1,0,1]
  v_fmac_f32 v122, v174, v114
  v_fmac_f32 v126, v178, v114
  s_cbranch_scc1 L_final
L_pr2:
  s_ff1_i32_b32 s78, s79
  s_lshl_b32 s66, s78, 12
L_pf2:
  buffer_load_dwordx4 v[172:175], v4, s[72:75], s66 offen offset:0 sc1
  buffer_load_dwordx4 v[176:179], v4, s[72:75], s66 offen offset:1024 sc1
  buffer_load_dwordx4 v[180:183], v4, s[72:75], s66 offen offset:2048 sc1
  s_branch L_poll
L_final:
  v_pk_mul_f32 v[120:121], v[120:121], v[116:117] op_sel_hi:[1,0]
  v_pk_mul_f32 v[124:125], v[124:125], v[116:117] op_sel_hi:[1,0]
  v_pk_mul_f32 v[128:129], v[128:129], v[116:117] op_sel_hi:[1,0]
  v_mul_f32 v122, v122, v116
  v_mul_f32 v126, v126, v116
  v_cvt_pk_bf16_f32 v8, v120, v121
  v_cvt_pk_bf16_f32 v9, v124, v125
  v_cvt_pk_bf16_f32 v10, v128, v129
  v_cvt_pk_bf16_f32 v11, v122, v126
  buffer_store_dwordx4 v[8:11], v4, s[56:59], s62 offen
  s_endpgm
L_uslow:
  s_nop 3
  ds_write_b128 v5, v[24:27]
  ds_write_b128 v5, v[28:31] offset:1024
  s_mov_b64 exec, s[86:87]
  ds_add_rtn_u32 v87, v146, v86 offset:4352
  s_mov_b64 exec, s[88:89]
  ds_read_b64 v[90:91], v85 offset:4096
  ds_read_b128 v[104:107], v82
  ds_read_b128 v[108:111], v82 offset:1024
  s_waitcnt lgkmcnt(3)
  v_readfirstlane_b32 s41, v87
  s_cmp_eq_u32 s41, 1
  s_cbranch_scc0 L_uend
  s_cmp_eq_u32 s67, 1
  s_cbranch_scc1 L_uret
  s_waitcnt lgkmcnt(2)
  v_max3_f32 v144, v88, v92, v90
  v_sub_f32 v184, v88, v144
  v_sub_f32 v186, v92, v144
  v_sub_f32 v188, v90, v144
  v_exp_f32 v184, v184
  v_exp_f32 v186, v186
  v_exp_f32 v188, v188
  s_nop 0
  v_mul_f32 v145, v184, v89
  v_fmac_f32 v145, v186, v93
  v_fmac_f32 v145, v188, v91
  v_pk_mul_f32 v[120:121], v[96:97], v[186:187] op_sel_hi:[1,0]
  v_pk_mul_f32 v[124:125], v[98:99], v[186:187] op_sel_hi:[1,0]
  v_pk_mul_f32 v[128:129], v[100:101], v[186:187] op_sel_hi:[1,0]
  v_mul_f32 v122, v102, v186
  v_mul_f32 v126, v103, v186
  v_cndmask_b32 v130, v144, v145, vcc
L_uret:
  s_cmp_lg_u32 s74, 0
  s_waitcnt lgkmcnt(0)
  s_cbranch_scc1 L_ufc
  s_branch L_ufp
L_uend:
  s_waitcnt vmcnt(0)
  s_branch L_done
L_pubfar:
  buffer_store_dwordx4 v[120:123], v4, s[44:47], s43 offen offset:0 sc1
  buffer_store_dwordx4 v[124:127], v4, s[44:47], s43 offen offset:1024 sc1
  buffer_store_dwordx4 v[128:131], v4, s[44:47], s43 offen offset:2048 sc1
  s_endpgm
L_done:
  s_endpgm
L_svc:
  s_memrealtime s[48:49]
  v_and_b32 v6, 0xf0, v4
  s_lshl_b32 s41, s37, 14
  s_mov_b32 s46, 0x4000
  s_mov_b32 s47, 0x20000
  s_lshl_b32 s43, s38, 12
  s_getreg_b32 s80, hwreg(HW_REG_XCC_ID, 0, 4)
  s_mov_b32 s81, 0
  v_mov_b32 v2, 0xff800000
  v_mov_b32 v3, 0
  v_mov_b32 v24, 0
  v_mov_b32 v25, 0
  v_mov_b32 v26, 0
  v_mov_b32 v27, 0
  v_mov_b32 v28, 0
  v_mov_b32 v29, 0
  v_mov_b32 v30, 0
  v_mov_b32 v31, 0
  v_lshrrev_b32 v5, 8, v4
  v_lshlrev_b32 v5, 5, v5
  v_lshrrev_b32 v49, 2, v4
  v_mov_b32 v7, 0
  s_mov_b64 s[78:79], 0
  s_waitcnt lgkmcnt(0)
  s_bitset1_b32 s49, 31
  s_cmp_lg_u32 s2, 0
  s_cbranch_scc1 L_noep
  s_mov_b64 s[76:77], s[48:49]
  s_atomic_cmpswap_x2 s[76:79], s[18:19], 0
L_noep:
  s_add_u32 s44, s20, s41
  s_addc_u32 s45, s21, 0
  s_mov_b32 s28, s16
  s_mov_b32 s29, s17
  s_mov_b32 s30, 0x10000
  s_mov_b32 s31, 0x20000
  s_add_u32 s56, s20, 0x100000
  s_addc_u32 s57, s21, 0
  s_mov_b32 s58, 0x10000
  s_mov_b32 s59, 0x20000
  s_add_u32 s3, s48, 0x40000000
  v_mov_b32 v1, s3
  ds_write_b32 v49, v1 offset:4608
  ds_write_b32 v49, v7 offset:4352
  s_cmp_eq_u32 s38, 3
  s_cselect_b32 s3, s42, s30
  s_mov_b64 exec, 1
  buffer_load_dword v22, v4, s[28:31], s3 offen sc1
  s_mov_b64 exec, -1
  s_cmp_lg_u32 s38, 0
  s_cbranch_scc1 L_notree
  s_mov_b32 s32, s4
  s_mov_b32 s33, s5
  buffer_load_dwordx4 v[8:11], v4, s[32:35], s42 offen
  s_mov_b32 s24, s10
  s_mov_b32 s25, s11
  s_mov_b32 s26, 0x4000
  s_mov_b32 s27, 0x20000
  s_lshl_b32 s41, s37, 8
  buffer_load_dwordx4 v[12:15], v6, s[24:27], s41 offen
  s_mov_b32 s68, s12
  s_mov_b32 s69, s13
  s_mov_b32 s70, 0x4000
  s_mov_b32 s71, 0x20000
  buffer_load_dwordx4 v[16:19], v6, s[68:71], s41 offen
  s_mov_b32 s72, s14
  s_mov_b32 s73, s15
  s_mov_b32 s74, 16
  s_mov_b32 s75, 0x20000
  s_lshr_b32 s41, s37, 3
  s_lshl_b32 s41, s41, 1
  buffer_load_ushort v20, v3, s[72:75], s41 offen
  s_mov_b32 s61, 0xd028965f
  s_waitcnt vmcnt(0)
  v_lshlrev_b32 v40, 16, v8
  v_lshlrev_b32 v41, 16, v12
  v_and_b32 v42, 0xffff0000, v8
  v_and_b32 v43, 0xffff0000, v12
  v_fmac_f32 v3, v40, v41
  v_fmac_f32 v3, v42, v43
  v_lshlrev_b32 v24, 16, v16
  v_and_b32 v25, 0xffff0000, v16
  v_lshlrev_b32 v40, 16, v9
  v_lshlrev_b32 v41, 16, v13
  v_and_b32 v42, 0xffff0000, v9
  v_and_b32 v43, 0xffff0000, v13
  v_fmac_f32 v3, v40, v41
  v_fmac_f32 v3, v42, v43
  v_lshlrev_b32 v26, 16, v17
  v_and_b32 v27, 0xffff0000, v17
  v_lshlrev_b32 v40, 16, v10
  v_lshlrev_b32 v41, 16, v14
  v_and_b32 v42, 0xffff0000, v10
  v_and_b32 v43, 0xffff0000, v14
  v_fmac_f32 v3, v40, v41
  v_fmac_f32 v3, v42, v43
  v_lshlrev_b32 v28, 16, v18
  v_and_b32 v29, 0xffff0000, v18
  v_lshlrev_b32 v40, 16, v11
  v_lshlrev_b32 v41, 16, v15
  v_and_b32 v42, 0xffff0000, v11
  v_and_b32 v43, 0xffff0000, v15
  v_fmac_f32 v3, v40, v41
  v_fmac_f32 v3, v42, v43
  v_lshlrev_b32 v30, 16, v19
  v_and_b32 v31, 0xffff0000, v19
  s_nop 1
  v_add_f32_dpp v3, v3, v3 row_ror:8 row_mask:0xf bank_mask:0xf
  s_nop 1
  v_add_f32_dpp v3, v3, v3 row_ror:4 row_mask:0xf bank_mask:0xf
  s_nop 1
  v_add_f32_dpp v3, v3, v3 row_ror:2 row_mask:0xf bank_mask:0xf
  s_nop 1
  v_add_f32_dpp v3, v3, v3 row_ror:1 row_mask:0xf bank_mask:0xf
  v_lshlrev_b32 v20, 16, v20
  v_sub_f32 v20, 1.0, v20
  v_fma_f32 v3, v20, s61, v3
  v_mul_f32 v2, s40, v3
  v_mov_b32 v3, 1.0
L_notree:
  ds_write_b64 v5, v[2:3] offset:4112
  v_mov_b32 v40, -1
  v_mov_b32 v41, -1
  v_mov_b32 v42, -1
  v_mov_b32 v43, -1
  ds_write_b128 v5, v[40:43] offset:4096
  ds_write_b128 v4, v[24:27] offset:5120
  ds_write_b128 v4, v[28:31] offset:6144
  s_lshr_b32 s82, s2, 3
  s_lshr_b32 s3, s2, 6
  s_add_u32 s82, s82, s3
  s_add_u32 s82, s82, s2
  s_and_b32 s82, s82, 7
  s_lshl_b32 s3, s3, 3
  s_and_b32 s41, s2, 7
  s_add_u32 s3, s3, s41
  s_lshl_b32 s3, s3, 6
  v_add_u32 v46, s3, v49
  v_and_b32 v47, 0x1f0, v4
  v_lshlrev_b32 v47, 2, v47
  v_lshrrev_b32 v48, 4, v4
  v_cvt_f32_u32 v48, v48
  s_sub_u32 s83, s48, 0x200
  v_and_b32 v6, 0x30, v4
  v_lshlrev_b32 v6, 8, v6
  s_waitcnt vmcnt(0) lgkmcnt(0)
  s_barrier
  s_memrealtime s[50:51]
  s_load_dwordx2 s[76:77], s[18:19], 0
  s_waitcnt lgkmcnt(0)
  s_cmp_eq_u32 s82, 0
  s_cselect_b32 s3, 0, s58
  v_mov_b32 v9, s50
  s_mov_b64 exec, 0xffff
  buffer_store_dword v9, v46, s[56:59], s3 offen sc1
  s_mov_b64 exec, -1
  s_cmp_lg_u32 s77, 0
  s_cbranch_scc1 L_ep
  s_mov_b64 s[76:77], s[48:49]
  s_atomic_cmpswap_x2 s[76:79], s[18:19], 0 glc
  s_waitcnt lgkmcnt(0)
  s_cmp_lg_u32 s77, 0
  s_cselect_b64 s[76:77], s[76:77], s[48:49]
L_ep:
  s_xor_b32 s15, s76, s77
  v_mov_b32 v52, s76
  v_mov_b32 v53, s15
  v_mov_b32 v54, s80
  v_mov_b32 v55, 0
  s_cmp_eq_u32 s38, 3
  s_cselect_b32 s43, s43, s46
  s_mov_b64 exec, 0xf
  buffer_store_dwordx4 v[52:55], v4, s[44:47], s43 offen offset:3072 sc1
  ds_write_b64 v7, v[52:53] offset:4360
  s_mov_b64 exec, -1
  s_waitcnt lgkmcnt(0)
  s_barrier
  s_memrealtime s[50:51]
  s_mov_b32 s3, 0
  buffer_load_dword v12, v47, s[56:59], s3 offen sc1
  s_waitcnt lgkmcnt(0)
  s_cmp_eq_u32 s82, 1
  s_cselect_b32 s3, 4352, s58
  v_mov_b32 v9, s50
  s_mov_b64 exec, 0xffff
  buffer_store_dword v9, v46, s[56:59], s3 offen sc1
  s_mov_b64 exec, -1
  s_waitcnt vmcnt(1)
  s_sub_u32 s3, s50, s83
  v_subrev_u32 v12, s83, v12
  v_cmp_gt_u32 vcc, s3, v12
  s_nop 1
  v_cndmask_b32 v12, 0, v12, vcc
  s_bcnt1_i32_b32 s41, vcc_lo
  s_nop 1
  v_add_u32_dpp v12, v12, v12 row_ror:8 row_mask:0xf bank_mask:0xf
  s_nop 1
  v_add_u32_dpp v12, v12, v12 row_ror:4 row_mask:0xf bank_mask:0xf
  s_nop 1
  v_add_u32_dpp v12, v12, v12 row_ror:2 row_mask:0xf bank_mask:0xf
  s_nop 1
  v_add_u32_dpp v12, v12, v12 row_ror:1 row_mask:0xf bank_mask:0xf
  v_mov_b32 v13, v12
  v_cvt_f32_u32 v14, s41
  s_nop 0
  v_permlane16_swap_b32 v12, v13
  v_add_u32 v12, v12, v13
  v_rcp_f32 v14, v14
  v_cvt_f32_u32 v12, v12
  s_cmp_lt_u32 s41, 24
  s_cselect_b32 s3, 0x7fc00000, 0
  v_fma_f32 v120, v12, v14, s3
  s_waitcnt lgkmcnt(0)
  s_barrier
  s_memrealtime s[50:51]
  s_mov_b32 s3, 4352
  buffer_load_dword v12, v47, s[56:59], s3 offen sc1
  s_cmp_eq_u32 s38, 3
  s_cselect_b32 s3, s46, 12288
  s_mov_b64 exec, 1
  buffer_load_dwordx4 v[16:19], v7, s[44:47], s3 offen offset:3072 sc1
  s_mov_b64 exec, -1
  s_waitcnt lgkmcnt(0)
  s_cmp_eq_u32 s82, 2
  s_cselect_b32 s3, 8704, s58
  v_mov_b32 v9, s50
  s_mov_b64 exec, 0xffff
  buffer_store_dword v9, v46, s[56:59], s3 offen sc1
  s_mov_b64 exec, -1
  s_waitcnt vmcnt(1)
  v_xor_b32 v16, v16, v52
  v_xor_b32 v17, v17, v53
  v_xor_b32 v18, v18, v54
  v_or3_b32 v16, v16, v17, v18
  v_cmp_ne_u32 vcc, 0, v16
  s_bitcmp0_b32 vcc_lo, 0
  s_cselect_b32 s81, 1, 0
  v_mov_b32 v16, s81
  ds_write_b32 v7, v16 offset:4368
  s_sub_u32 s3, s50, s83
  v_subrev_u32 v12, s83, v12
  v_cmp_gt_u32 vcc, s3, v12
  s_nop 1
  v_cndmask_b32 v12, 0, v12, vcc
  s_bcnt1_i32_b32 s41, vcc_lo
  s_nop 1
  v_add_u32_dpp v12, v12, v12 row_ror:8 row_mask:0xf bank_mask:0xf
  s_nop 1
  v_add_u32_dpp v12, v12, v12 row_ror:4 row_mask:0xf bank_mask:0xf
  s_nop 1
  v_add_u32_dpp v12, v12, v12 row_ror:2 row_mask:0xf bank_mask:0xf
  s_nop 1
  v_add_u32_dpp v12, v12, v12 row_ror:1 row_mask:0xf bank_mask:0xf
  v_mov_b32 v13, v12
  v_cvt_f32_u32 v14, s41
  s_nop 0
  v_permlane16_swap_b32 v12, v13
  v_add_u32 v12, v12, v13
  v_rcp_f32 v14, v14
  v_cvt_f32_u32 v12, v12
  s_cmp_lt_u32 s41, 24
  s_cselect_b32 s3, 0x7fc00000, 0
  v_fma_f32 v121, v12, v14, s3
  v_sub_f32 v13, v121, v120
  v_mul_f32 v13, 0x3e800000, v13
  v_add_f32 v13, 0x3f800000, v13
  v_subrev_f32 v14, 0x41300000, v48
  v_fma_f32 v14, v14, v13, v121
  v_add_f32 v14, 0xc2a00000, v14
  v_cmp_o_f32 vcc, v14, v14
  v_max_f32 v14, 0, v14
  v_cvt_u32_f32 v14, v14
  v_add_u32 v14, s83, v14
  s_and_b64 exec, exec, vcc
  ds_write_b32 v49, v14 offset:4608
  s_mov_b64 exec, -1
  s_waitcnt lgkmcnt(0)
  s_barrier
  s_memrealtime s[50:51]
  s_mov_b32 s3, 8704
  buffer_load_dword v12, v47, s[56:59], s3 offen sc1
  s_waitcnt lgkmcnt(0)
  s_cmp_eq_u32 s82, 3
  s_cselect_b32 s3, 13056, s58
  v_mov_b32 v9, s50
  s_mov_b64 exec, 0xffff
  buffer_store_dword v9, v46, s[56:59], s3 offen sc1
  s_mov_b64 exec, -1
  s_waitcnt vmcnt(1)
  s_sub_u32 s3, s50, s83
  v_subrev_u32 v12, s83, v12
  v_cmp_gt_u32 vcc, s3, v12
  s_nop 1
  v_cndmask_b32 v12, 0, v12, vcc
  s_bcnt1_i32_b32 s41, vcc_lo
  s_nop 1
  v_add_u32_dpp v12, v12, v12 row_ror:8 row_mask:0xf bank_mask:0xf
  s_nop 1
  v_add_u32_dpp v12, v12, v12 row_ror:4 row_mask:0xf bank_mask:0xf
  s_nop 1
  v_add_u32_dpp v12, v12, v12 row_ror:2 row_mask:0xf bank_mask:0xf
  s_nop 1
  v_add_u32_dpp v12, v12, v12 row_ror:1 row_mask:0xf bank_mask:0xf
  v_mov_b32 v13, v12
  v_cvt_f32_u32 v14, s41
  s_nop 0
  v_permlane16_swap_b32 v12, v13
  v_add_u32 v12, v12, v13
  v_rcp_f32 v14, v14
  v_cvt_f32_u32 v12, v12
  s_cmp_lt_u32 s41, 24
  s_cselect_b32 s3, 0x7fc00000, 0
  v_fma_f32 v122, v12, v14, s3
  v_sub_f32 v13, v122, v120
  v_mul_f32 v13, 0x3e000000, v13
  v_add_f32 v13, 0x3f800000, v13
  v_subrev_f32 v14, 0x41700000, v48
  v_fma_f32 v14, v14, v13, v122
  v_add_f32 v14, 0xc2980000, v14
  v_cmp_o_f32 vcc, v14, v14
  v_max_f32 v14, 0, v14
  v_cvt_u32_f32 v14, v14
  v_add_u32 v14, s83, v14
  s_and_b64 exec, exec, vcc
  ds_write_b32 v49, v14 offset:4608
  s_mov_b64 exec, -1
  s_waitcnt lgkmcnt(0)
  s_barrier
  s_memrealtime s[50:51]
  s_mov_b32 s3, 13056
  buffer_load_dword v12, v47, s[56:59], s3 offen sc1
  s_waitcnt lgkmcnt(0)
  s_cmp_eq_u32 s82, 4
  s_cselect_b32 s3, 17408, s58
  v_mov_b32 v9, s50
  s_mov_b64 exec, 0xffff
  buffer_store_dword v9, v46, s[56:59], s3 offen sc1
  s_mov_b64 exec, -1
  s_waitcnt vmcnt(1)
  s_sub_u32 s3, s50, s83
  v_subrev_u32 v12, s83, v12
  v_cmp_gt_u32 vcc, s3, v12
  s_nop 1
  v_cndmask_b32 v12, 0, v12, vcc
  s_bcnt1_i32_b32 s41, vcc_lo
  s_nop 1
  v_add_u32_dpp v12, v12, v12 row_ror:8 row_mask:0xf bank_mask:0xf
  s_nop 1
  v_add_u32_dpp v12, v12, v12 row_ror:4 row_mask:0xf bank_mask:0xf
  s_nop 1
  v_add_u32_dpp v12, v12, v12 row_ror:2 row_mask:0xf bank_mask:0xf
  s_nop 1
  v_add_u32_dpp v12, v12, v12 row_ror:1 row_mask:0xf bank_mask:0xf
  v_mov_b32 v13, v12
  v_cvt_f32_u32 v14, s41
  s_nop 0
  v_permlane16_swap_b32 v12, v13
  v_add_u32 v12, v12, v13
  v_rcp_f32 v14, v14
  v_cvt_f32_u32 v12, v12
  s_cmp_lt_u32 s41, 24
  s_cselect_b32 s3, 0x7fc00000, 0
  v_fma_f32 v123, v12, v14, s3
  v_sub_f32 v13, v123, v120
  v_mul_f32 v13, 0x3daaaaab, v13
  v_add_f32 v13, 0x3f800000, v13
  v_subrev_f32 v14, 0x41980000, v48
  v_fma_f32 v14, v14, v13, v123
  v_add_f32 v14, 0xc2900000, v14
  v_cmp_o_f32 vcc, v14, v14
  v_max_f32 v14, 0, v14
  v_cvt_u32_f32 v14, v14
  v_add_u32 v14, s83, v14
  s_and_b64 exec, exec, vcc
  ds_write_b32 v49, v14 offset:4608
  s_mov_b64 exec, -1
  s_waitcnt lgkmcnt(0)
  s_barrier
  s_memrealtime s[50:51]
  s_mov_b32 s3, 17408
  buffer_load_dword v12, v47, s[56:59], s3 offen sc1
  s_waitcnt lgkmcnt(0)
  s_waitcnt vmcnt(0)
  s_sub_u32 s3, s50, s83
  v_subrev_u32 v12, s83, v12
  v_cmp_gt_u32 vcc, s3, v12
  s_nop 1
  v_cndmask_b32 v12, 0, v12, vcc
  s_bcnt1_i32_b32 s41, vcc_lo
  s_nop 1
  v_add_u32_dpp v12, v12, v12 row_ror:8 row_mask:0xf bank_mask:0xf
  s_nop 1
  v_add_u32_dpp v12, v12, v12 row_ror:4 row_mask:0xf bank_mask:0xf
  s_nop 1
  v_add_u32_dpp v12, v12, v12 row_ror:2 row_mask:0xf bank_mask:0xf
  s_nop 1
  v_add_u32_dpp v12, v12, v12 row_ror:1 row_mask:0xf bank_mask:0xf
  v_mov_b32 v13, v12
  v_cvt_f32_u32 v14, s41
  s_nop 0
  v_permlane16_swap_b32 v12, v13
  v_add_u32 v12, v12, v13
  v_rcp_f32 v14, v14
  v_cvt_f32_u32 v12, v12
  s_cmp_lt_u32 s41, 24
  s_cselect_b32 s3, 0x7fc00000, 0
  v_fma_f32 v124, v12, v14, s3
  v_sub_f32 v13, v124, v120
  v_mul_f32 v13, 0x3d800000, v13
  v_add_f32 v13, 0x3f800000, v13
  v_subrev_f32 v14, 0x41b80000, v48
  v_fma_f32 v14, v14, v13, v124
  v_add_f32 v14, 0xc2880000, v14
  v_cmp_o_f32 vcc, v14, v14
  v_max_f32 v14, 0, v14
  v_cvt_u32_f32 v14, v14
  v_add_u32 v14, s83, v14
  s_and_b64 exec, exec, vcc
  ds_write_b32 v49, v14 offset:4608
  s_mov_b64 exec, -1
  s_waitcnt lgkmcnt(0)
  s_endpgm
L_end:
.section .rodata,"a"
.p2align 6
.amdhsa_kernel standalone__tree_speculative_verify_tree_attention_over_candidate_token_tree__sampling_kernel
  .amdhsa_next_free_vgpr 512
  .amdhsa_next_free_sgpr 100
  .amdhsa_accum_offset 256
  .amdhsa_group_segment_fixed_size 0
  .amdhsa_kernarg_size 72
  .amdhsa_user_sgpr_count 2
  .amdhsa_user_sgpr_kernarg_segment_ptr 1
  .amdhsa_system_sgpr_workgroup_id_x 1
.end_amdhsa_kernel
```
